```python
import torch

def _softmax(x, axis=-1):
    return torch.softmax(x, dim=axis)
def _gelu(x):
    return torch.nn.functional.gelu(x, approximate="tanh")
def _silu(x):
    return torch.nn.functional.silu(x)
def _sigmoid(x):
    return torch.sigmoid(x)
def _layernorm(x, axis=-1, eps=1e-5):
    m = x.mean(dim=axis, keepdim=True)
    v = x.var(dim=axis, keepdim=True, unbiased=False)
    return (x - m) / torch.sqrt(v + eps)
def _scatter_add(tgt, idx, src, axis=0):
    return tgt.clone().index_add_(axis, idx, src)
def _segment_sum(src, seg, n):
    out = torch.zeros((n,) + src.shape[1:], dtype=src.dtype)
    return out.index_add_(0, seg, src)
def _pad(x, pw):
    flat = tuple(v for pair in reversed(pw) for v in pair)
    return torch.nn.functional.pad(x, flat)

kernel_name = 'interleave_layers__sliding_block_cached__glu_gated_swiglu__decode'

def setup_inputs():

    _w = (lambda a: (lambda t: t.to(torch.bfloat16) if t.is_floating_point() else t)(torch.as_tensor(a)))
    def _A_setup():
        B, Sq, D = 1, 1, 512
        Hq, Hkv, Sk, Dh = 32, 32, 4096, 128
        assert Hq % Hkv == 0, (Hq, Hkv)
        return {
            "x": _w((lambda *s: torch.randn(*s, dtype=torch.bfloat16) * 0.05)(B, Sq, D)),
            "k_cache": _w((lambda *s: torch.randn(*s, dtype=torch.bfloat16) * 0.8)(B, Hkv, Sk, Dh)),
            "v_cache": _w((lambda *s: torch.randn(*s, dtype=torch.bfloat16) * 0.8)(B, Hkv, Sk, Dh)),
            "wq": _w((lambda *s: torch.randn(*s, dtype=torch.bfloat16) * 0.8)(D, Hq * Dh) * (D ** -0.5)),
            "wo": _w((lambda *s: torch.randn(*s, dtype=torch.bfloat16) * 0.8)(Hq * Dh, D) * ((Hq * Dh) ** -0.5)),
        }
    _A_in = _A_setup()

    def _B_setup():
        B, S, D, F = 1, 1, 512, 1376
        return {
            "x": _w((lambda *s: torch.randn(*s, dtype=torch.bfloat16) * 0.05)(B, S, D)),
            "w1": _w((lambda *s: torch.randn(*s, dtype=torch.bfloat16) * 0.2)(D, F) * (2.0 / D) ** 0.5),
            "w3": _w((lambda *s: torch.randn(*s, dtype=torch.bfloat16) * 0.2)(D, F) * (2.0 / D) ** 0.5),
            "w2": _w((lambda *s: torch.randn(*s, dtype=torch.bfloat16) * 0.2)(F, D) * (2.0 / F) ** 0.5),
        }
    _B_in = _B_setup()

    return {
        "A_x": _A_in["x"],
        "A_k_cache": _A_in["k_cache"],
        "A_v_cache": _A_in["v_cache"],
        "A_wq": _A_in["wq"],
        "A_wo": _A_in["wo"],
        "B_x": _B_in["x"],
        "B_w1": _B_in["w1"],
        "B_w3": _B_in["w3"],
        "B_w2": _B_in["w2"],
    }

def reference(A_x, A_k_cache, A_v_cache, A_wq, A_wo, B_x, B_w1, B_w3, B_w2):
    def _A_ref(x, k_cache, v_cache, wq, wo):
        B, Sq, D = x.shape
        Hq, Dh = 32, 128
        Hkv, Sk = k_cache.shape[1], k_cache.shape[2]
        W = min(4096, max(256, Sk // 4))
        rep = Hq // Hkv
        q = (lambda x, *d: x.permute(*d))((x @ wq).reshape(B, Sq, Hq, Dh), 0, 2, 1, 3)
        k = (lambda x, n, axis: torch.repeat_interleave(x, n, dim=axis))(k_cache[:, :, Sk - W:, :], rep, axis=1)
        v = (lambda x, n, axis: torch.repeat_interleave(x, n, dim=axis))(v_cache[:, :, Sk - W:, :], rep, axis=1)
        scores = torch.einsum("bhqd,bhkd->bhqk", q, k) * (Dh ** -0.5)
        p = _softmax(scores, axis=-1)
        o = torch.einsum("bhqk,bhkd->bhqd", p, v)
        return (lambda x, *d: x.permute(*d))(o, 0, 2, 1, 3).reshape(B, Sq, Hq * Dh) @ wo

    def _B_ref(x, w1, w3, w2):
        gate = torch.einsum("bsd,df->bsf", x, w1)
        up = torch.einsum("bsd,df->bsf", x, w3)
        h = _silu(gate) * up
        out = torch.einsum("bsf,fd->bsd", h, w2)
        return out

    x = A_x
    x = x + _A_ref(_layernorm(x, axis=-1), A_k_cache, A_v_cache, A_wq, A_wo)
    x = x + _B_ref(_layernorm(x, axis=-1), B_w1, B_w3, B_w2)
    x = x + _A_ref(_layernorm(x, axis=-1), A_k_cache, A_v_cache, A_wq, A_wo)
    x = x + _B_ref(_layernorm(x, axis=-1), B_w1, B_w3, B_w2)
    return x
```

```asm
; @launch grid=(256,1,1) block=(256,1,1) lds=124928
.amdgcn_target "amdgcn-amd-amdhsa--gfx950"
.text
.p2align 12
.globl interleave_layers__sliding_block_cached__glu_gated_swiglu__decode_kernel
.p2align 8
.type interleave_layers__sliding_block_cached__glu_gated_swiglu__decode_kernel,@function
interleave_layers__sliding_block_cached__glu_gated_swiglu__decode_kernel:
    s_cmp_ge_u32 s2, 256
    s_cbranch_scc1 L_end
    s_load_dwordx16 s[4:19], s[0:1], 0
    s_load_dwordx8 s[20:27], s[0:1], 64
    s_getpc_b64 s[42:43]
L_pc:
    v_lshlrev_b32 v152, 6, v0
    v_min_u32 v152, L_fastend-L_pc-64, v152
    s_cmp_lt_u32 s2, 32
    s_cselect_b64 exec, -1, 1
    global_load_dword v174, v152, s[42:43]
    s_mov_b64 exec, -1
    v_lshrrev_b32 v152, 6, v0
    v_and_b32 v1, 63, v0
    v_readfirstlane_b32 s28, v152
    s_lshr_b32 s3, s2, 3
    s_and_b32 s29, s3, 7
    s_lshr_b32 s3, s3, 3
    s_and_b32 s31, s2, 7
    s_lshl_b32 s30, s31, 2
    s_add_u32 s30, s30, s3
    v_lshrrev_b32 v153, 4, v1
    v_and_b32 v154, 15, v1
    v_lshlrev_b32 v162, 1, v153
    v_xor_b32 v162, v162, v154
    v_lshlrev_b32 v162, 4, v162
    v_lshl_add_u32 v160, v153, 13, v162
    v_xor_b32 v161, 0x80, v160
    v_add_u32 v161, 63488, v161
    s_lshl_b32 s49, s28, 12
    s_lshl_b32 s55, s29, 19
    s_lshl_b32 s56, s28, 17
    s_add_u32 s55, s55, s56
    s_lshl_b32 s56, s30, 8
    s_add_u32 s55, s55, s56
    s_add_u32 m0, s49, 4096
    s_waitcnt lgkmcnt(0)
    s_add_u32 s10, s10, s55
    s_addc_u32 s11, s11, 0
    global_load_lds_dwordx4 v160, s[10:11] offset:0 nt
    v_add_u32 v160, 31744, v160
    s_load_dword s32, s[26:27], 0
    global_load_lds_dwordx4 v160, s[10:11] offset:1024 nt
    global_load_lds_dwordx4 v161, s[10:11] offset:2048 nt
    v_add_u32 v161, 31744, v161
    global_load_lds_dwordx4 v161, s[10:11] offset:3072 nt
    v_and_b32 v157, 3, v1
    v_lshl_add_u32 v158, v157, 2, v153
    s_lshl_b32 s48, s28, 5
    v_lshl_add_u32 v10, v158, 1, s48
    v_lshl_add_u32 v149, v153, 8, v162
    v_xor_b32 v150, 0x80, v149
    v_xor_b32 v164, v153, v154
    v_lshlrev_b32 v164, 4, v164
    v_lshl_add_u32 v164, v153, 8, v164
    v_xor_b32 v165, 64, v164
    v_xor_b32 v166, 128, v164
    v_xor_b32 v167, 192, v164
    s_lshl_b32 s48, s29, 7
    s_lshl_b32 s56, s30, 20
    s_lshl_b32 s58, s29, 15
    s_add_u32 s56, s56, s58
    s_lshl_b32 s58, s28, 13
    s_add_u32 s56, s56, s58
    s_add_u32 s56, s56, 786432
    s_add_u32 s4, s4, s48
    s_addc_u32 s5, s5, 0
    global_load_ushort v24, v10, s[4:5]
    s_add_u32 s6, s6, s56
    s_addc_u32 s7, s7, 0
    s_add_u32 m0, s58, 92160
    s_barrier
    global_load_lds_dwordx4 v164, s[6:7] offset:0 nt
    global_load_lds_dwordx4 v165, s[6:7] offset:1024 nt
    global_load_lds_dwordx4 v166, s[6:7] offset:2048 nt
    global_load_lds_dwordx4 v167, s[6:7] offset:3072 nt
    s_add_u32 m0, s58, 96256
    s_add_u32 s6, s6, 4096
    s_addc_u32 s7, s7, 0
    global_load_lds_dwordx4 v164, s[6:7] offset:0 nt
    global_load_lds_dwordx4 v165, s[6:7] offset:1024 nt
    global_load_lds_dwordx4 v166, s[6:7] offset:2048 nt
    global_load_lds_dwordx4 v167, s[6:7] offset:3072 nt
    v_lshl_add_u32 v2, v1, 4, s49
    s_lshl_b32 s57, s30, 14
    s_add_u32 s57, s57, 262144
    s_add_u32 s3, s48, s57
    s_add_u32 s59, s3, s49
    s_add_u32 s59, s59, 2048
    v_mov_b32 v163, s59
    v_cmp_lt_u32 vcc, 2, v1
    s_add_u32 s3, s3, 3072
    v_mov_b32 v169, s3
    v_cndmask_b32 v163, v163, v169, vcc
    s_and_b32 s3, s48, 0x180
    s_add_u32 s3, s3, s57
    s_add_u32 s3, s3, 11264
    v_writelane_b32 v163, s3, 5
    global_load_dword v174, v163, s[26:27]
    s_add_u32 s8, s8, s56
    s_addc_u32 s9, s9, 0
    s_add_u32 s38, s26, s57
    s_addc_u32 s39, s27, 0
    s_lshl_b32 s55, s29, 14
    s_add_u32 s55, s55, 1048576
    s_add_u32 s40, s26, s55
    s_addc_u32 s41, s27, 0
    s_add_u32 s14, s40, 0x40000
    s_addc_u32 s15, s41, 0
    s_getreg_b32 s35, hwreg(HW_REG_XCC_ID, 0, 4)
    s_and_b32 s31, s30, 15
    s_lshl_b32 s31, s31, 7
    s_lshr_b32 s59, s30, 4
    s_lshl_b32 s59, s59, 12
    s_add_u32 s31, s31, s59
    s_add_u32 s31, s31, s55
    s_add_u32 s31, s31, 0x20000
    s_mov_b32 s56, 0xffff0000
    s_mov_b32 s57, 0xffff0000
    s_mov_b32 s42, 0x10000
    s_mov_b32 s43, 0x10000
    s_mov_b32 s46, 0
    s_mov_b32 s47, -1
    v_mov_b32 v18, 0
    v_lshrrev_b32 v155, 3, v1
    v_and_b32 v156, 7, v1
    s_add_u32 s55, s49, s48
    v_and_b32 v160, 31, v1
    v_lshl_add_u32 v3, v160, 2, s55
    v_lshrrev_b32 v163, 5, v1
    v_lshl_add_u32 v3, v163, 10, v3
    s_lshl_b32 s55, s28, 6
    v_lshl_add_u32 v4, v160, 1, s55
    v_lshl_add_u32 v161, v156, 2, v153
    v_lshl_add_u32 v11, v161, 1, s55
    s_lshl_b32 s55, s30, 6
    s_add_u32 s55, s55, s49
    v_lshl_add_u32 v5, v154, 2, s55
    v_and_b32 v162, 1, v153
    v_mul_u32_u24 v162, 0x22000, v162
    v_xor_b32 v5, v5, v162
    v_lshl_add_u32 v148, v156, 3, s55
    v_xor_b32 v148, v148, v162
    v_and_b32 v162, 1, v155
    v_lshl_add_u32 v148, v162, 11, v148
    v_lshl_add_u32 v148, v163, 18, v148
    s_lshl_b32 s55, s29, 2
    s_add_u32 s55, s55, s28
    s_lshl_b32 s55, s55, 4
    s_add_u32 s55, s55, 3072
    v_mov_b32 v6, s55
    v_lshl_add_u32 v9, v163, 3, s55
    v_lshlrev_b32 v161, 4, v157
    v_lshl_add_u32 v161, v155, 6, v161
    v_add_u32 v7, 3072, v161
    v_mov_b32 v162, 0xff
    v_cmp_eq_u32 vcc, 0, v157
    v_lshlrev_b32 v13, 4, v153
    v_and_b32 v161, 8, v1
    v_cndmask_b32 v8, 0, v162, vcc
    v_lshl_add_u32 v14, v161, 4, v13
    s_lshl_b32 s55, s28, 2
    v_mov_b32 v19, s55
    v_lshlrev_b32 v29, 2, v157
    v_lshlrev_b32 v160, 2, v160
    v_mov_b32 v161, 0x3f803f80
    ds_write_b32 v160, v161 offset:128
    v_lshlrev_b32 v160, 2, v156
    ds_write_b32 v160, v18 offset:864
    v_mov_b32 v15, v2
    v_mov_b32 v16, v15
    v_mov_b32 v235, s35
    v_lshrrev_b32 v168, 2, v154
    v_and_b32 v160, 1, v153
    v_lshl_add_u32 v161, v160, 2, v168
    v_lshlrev_b32 v161, 1, v161
    v_xor_b32 v161, s55, v161
    v_lshlrev_b32 v161, 4, v161
    v_lshl_add_u32 v161, v157, 3, v161
    v_lshl_add_u32 v162, v153, 3, v168
    v_lshl_add_u32 v20, v162, 8, v161
    v_xor_b32 v21, 32, v20
    v_lshrrev_b32 v161, 1, v168
    v_lshl_add_u32 v161, v160, 1, v161
    v_xor_b32 v161, s28, v161
    v_lshlrev_b32 v161, 5, v161
    v_lshl_add_u32 v161, v157, 3, v161
    v_lshl_add_u32 v22, v162, 7, v161
    v_add_u32 v22, 53248, v22
    s_mov_b32 s36, 0x40000
    s_mov_b32 s50, 0x3e0293ee
    s_mov_b32 s51, 0xffffff00
    s_mov_b32 s52, 0x3b000000
    s_mov_b32 s53, 0x3727c5ac
    s_mov_b32 s54, 0xbfb8aa3b
    s_and_b32 s55, s30, 28
    s_lshr_b32 s34, 0x56446666, s55
    s_and_b32 s34, s34, 15
    s_lshl_b32 s55, s55, 1
    s_mov_b32 s24, 0x120c0600
    s_mov_b32 s25, 0x26201c18
    s_lshr_b64 s[24:25], s[24:25], s55
    s_and_b32 s55, s24, 0xff
    s_lshl_b32 s55, s55, 2
    s_and_b32 s33, s30, 3
    s_mul_i32 s33, s33, s34
    s_add_u32 s33, s33, s55
    s_sub_u32 s37, s34, 1
    s_lshl_b32 s34, s34, 3
    v_and_b32 v161, 4, v1
    v_cmp_eq_u32 vcc, 0, v161
    v_add_u32 v161, 768, v10
    v_mov_b32 v162, 960
    v_cndmask_b32 v12, v162, v161, vcc
    v_lshrrev_b32 v161, 1, v10
    v_cmp_gt_u32 vcc, s34, v161
    s_nop 1
    v_cndmask_b32 v23, 0, -1, vcc
    v_and_b32 v160, 2, v155
    v_xor_b32 v160, v160, v156
    v_lshlrev_b32 v161, 4, v160
    v_lshl_add_u32 v144, v155, 10, v161
    v_xor_b32 v145, 64, v144
    v_add_u32 v145, 7168, v145
    v_mul_u32_u24 v162, 2752, v155
    v_min_u32 v161, s37, v160
    v_lshl_add_u32 v146, v161, 4, v162
    v_xor_b32 v160, 4, v160
    v_min_u32 v161, s37, v160
    v_lshl_add_u32 v147, v161, 4, v162
    v_add_u32 v147, 20992, v147
    s_lshl_b32 s55, s30, 17
    s_lshl_b32 s59, s28, 15
    s_add_u32 s55, s55, s59
    s_add_u32 s55, s55, s48
    s_add_u32 s12, s12, s55
    s_addc_u32 s13, s13, 0
    s_lshl_b32 s55, s29, 2
    s_add_u32 s55, s55, s28
    s_mul_i32 s55, s55, 44032
    s_lshl_b32 s59, s33, 4
    s_add_u32 s55, s55, s59
    s_add_u32 s16, s16, s55
    s_addc_u32 s17, s17, 0
    s_add_u32 s18, s18, s55
    s_addc_u32 s19, s19, 0
    s_lshl_b32 s55, s33, 13
    s_lshr_b32 s59, s37, 1
    s_min_u32 s59, s28, s59
    s_lshl_b32 s59, s59, 14
    s_add_u32 s55, s55, s59
    s_add_u32 s55, s55, s48
    s_add_u32 s20, s20, s55
    s_addc_u32 s21, s21, 0
    s_lshr_b32 s59, s59, 10
    s_add_u32 s59, s59, 8
    s_cmp_ge_u32 s59, s34
    s_cselect_b32 s59, 8192, 0
    s_sub_u32 s4, s20, s59
    s_subb_u32 s5, s21, 0
    s_add_u32 s22, s22, s48
    s_addc_u32 s23, s23, 0
    s_add_u32 s6, s8, 4096
    s_addc_u32 s7, s9, 0
    s_waitcnt lgkmcnt(0)
    s_add_u32 s60, s32, 0x5a3c7181
    s_add_u32 s61, s32, 0x5a3c7182
    s_add_u32 s62, s32, 0x5a3c7183
    s_add_u32 s63, s32, 0x5a3c7184
    s_add_u32 s64, s32, 0x5a3c7185
    s_add_u32 s65, s32, 0x5a3c7186
    s_add_u32 s66, s32, 0x5a3c7187
    s_add_u32 s67, s32, 0x5a3c7188
    s_add_u32 s68, s32, 0x5a3c7189
    s_add_u32 s69, s32, 0x5a3c718a
    v_mov_b32 v234, s60
    v_cndmask_b32 v237, v234, v235, s[46:47]
    v_add_u32 v164, 0x140000, v9
    v_add_u32 v165, 0x140000, v3
    v_add_u32 v166, 0x2000, v9
    s_waitcnt vmcnt(9)
    ds_write_b16 v10, v24 offset:0
    v_lshlrev_b32 v236, 16, v24
    v_lshlrev_b32 v24, 16, v24
    v_mul_f32 v159, v236, v236
    s_nop 1
    v_permlane32_swap_b32 v236, v159
    v_add_f32 v236, v236, v159
    s_nop 1
    v_add_f32_dpp v236, v236, v236 quad_perm:[1,0,3,2] row_mask:0xf bank_mask:0xf
    s_nop 1
    v_add_f32_dpp v236, v236, v236 quad_perm:[2,3,0,1] row_mask:0xf bank_mask:0xf
    s_nop 1
    v_add_f32_dpp v236, v236, v236 row_bcast:15 row_mask:0xa bank_mask:0xf
    s_mov_b64 exec, s[42:43]
    global_store_dwordx2 v166, v[236:237], s[38:39] offset:0
    s_mov_b64 exec, -1
    s_waitcnt lgkmcnt(0)
    s_barrier
    ds_read_b128 v[176:179], v14 offset:0
    ds_read_b64_tr_b16 v[32:33], v20 offset:4096
    ds_read_b64_tr_b16 v[34:35], v20 offset:5120
    ds_read_b64_tr_b16 v[40:41], v21 offset:4096
    ds_read_b64_tr_b16 v[42:43], v21 offset:5120
    ds_read_b128 v[180:183], v14 offset:64
    ds_read_b64_tr_b16 v[36:37], v20 offset:12288
    ds_read_b64_tr_b16 v[38:39], v20 offset:13312
    ds_read_b64_tr_b16 v[44:45], v21 offset:12288
    ds_read_b64_tr_b16 v[46:47], v21 offset:13312
    s_waitcnt lgkmcnt(7)
    v_mfma_f32_16x16x32_bf16 v[192:195], v[176:179], v[32:35], 0
    s_waitcnt lgkmcnt(5)
    v_mfma_f32_16x16x32_bf16 v[196:199], v[176:179], v[40:43], 0
    s_waitcnt lgkmcnt(2)
    v_mfma_f32_16x16x32_bf16 v[192:195], v[180:183], v[36:39], v[192:195]
    s_waitcnt lgkmcnt(0)
    v_mfma_f32_16x16x32_bf16 v[196:199], v[180:183], v[44:47], v[196:199]
    s_nop 7
    v_cndmask_b32 v152, v192, v196, s[56:57]
    v_bfi_b32 v152, v8, s60, v152
    global_store_dword v3, v152, s[38:39] offset:0
    v_mov_b32 v200, v165
    v_mov_b32 v201, v152
    v_mov_b32 v202, v164
    s_add_u32 m0, s58, 20480
    s_nop 0
    global_load_lds_dwordx4 v149, s[8:9] offset:0 nt
    global_load_lds_dwordx4 v149, s[8:9] offset:1024 nt
    global_load_lds_dwordx4 v150, s[8:9] offset:2048 nt
    global_load_lds_dwordx4 v150, s[8:9] offset:3072 nt
    s_add_u32 m0, s58, 24576
    s_nop 0
    global_load_lds_dwordx4 v149, s[6:7] offset:0 nt
    global_load_lds_dwordx4 v149, s[6:7] offset:1024 nt
    global_load_lds_dwordx4 v150, s[6:7] offset:2048 nt
    global_load_lds_dwordx4 v150, s[6:7] offset:3072 nt
    v_mov_b32 v168, s32
    v_mov_b32 v169, s32
    s_mov_b64 exec, 0xff00ff
    global_store_dwordx2 v148, v[168:169], s[40:41] offset:0 sc1
    s_mov_b64 exec, -1
    v_xor_b32 v160, v153, v154
    v_lshlrev_b32 v160, 4, v160
    v_lshl_add_u32 v160, v154, 8, v160
    s_add_u32 s55, s58, 92160
    v_add_u32 v160, s55, v160
    v_xor_b32 v161, 64, v160
    v_xor_b32 v162, 128, v160
    v_xor_b32 v163, 192, v160
    v_mov_b32 v165, v2
    v_lshlrev_b32 v166, 1, v2
    v_add_u32 v166, 0x140000, v166
    v_add_u32 v167, 0x2000, v7
    v_lshlrev_b32 v173, 1, v7
    v_add_u32 v173, 0x142000, v173
    s_branch L_page_1
.p2align 12
L_page_1:
    s_waitcnt vmcnt(15)
    global_load_dwordx4 v[248:251], v167, s[38:39] offset:0 sc1
    global_load_dwordx4 v[224:227], v165, s[38:39] offset:0 sc1
    global_load_dwordx4 v[228:231], v165, s[38:39] offset:1024 sc1
    s_waitcnt vmcnt(15)
    ds_read_b128 v[48:51], v160 offset:0
    ds_read_b128 v[52:55], v161 offset:0
    ds_read_b128 v[56:59], v162 offset:0
    ds_read_b128 v[60:63], v163 offset:0
    ds_read_b128 v[64:67], v160 offset:4096
    ds_read_b128 v[68:71], v161 offset:4096
    ds_read_b128 v[72:75], v162 offset:4096
    ds_read_b128 v[76:79], v163 offset:4096
    s_waitcnt vmcnt(6)
    s_add_u32 m0, s49, 53248
    s_nop 0
    global_load_lds_dwordx4 v144, s[12:13] offset:0 nt
    global_load_lds_dwordx4 v145, s[12:13] offset:1024 nt
    v_add_u32 v172, 14336, v144
    global_load_lds_dwordx4 v172, s[12:13] offset:2048 nt
    v_add_u32 v172, 14336, v145
    global_load_lds_dwordx4 v172, s[12:13] offset:3072 nt
    s_branch L_e1ent
L_e1top:
    s_sub_u32 s36, s36, 1
    s_cbranch_scc1 L_end
    s_bitcmp1_b32 s36, 0
    s_cbranch_scc1 L_e1plain
    global_store_dword v200, v201, s[38:39] offset:0 sc1
    s_waitcnt vmcnt(0)
    s_mov_b64 exec, s[42:43]
    global_store_dwordx2 v202, v[236:237], s[38:39] offset:0 sc1
    s_mov_b64 exec, -1
L_e1plain:
    global_load_dwordx4 v[248:251], v167, s[38:39] offset:0 sc1
    global_load_dwordx4 v[224:227], v165, s[38:39] offset:0 sc1
    global_load_dwordx4 v[228:231], v165, s[38:39] offset:1024 sc1
    v_sub_u32 v165, v166, v165
    v_sub_u32 v167, v173, v167
    s_waitcnt vmcnt(0)
L_e1ent:
    s_waitcnt vmcnt(4)
    v_bitop3_b32 v175, v224, v228, s60 bitop3:0x7e
    v_cmp_ne_u32 s[44:45], s60, v249
    v_cmp_ne_u32_sdwa vcc, v175, v18 src0_sel:BYTE_0 src1_sel:DWORD
    s_or_b64 vcc, vcc, s[44:45]
    s_cbranch_vccnz L_e1top
    v_cmp_ne_u32 vcc, s35, v251
    v_permlane32_swap_b32 v248, v250
    v_add_f32 v164, v248, v250
    v_and_b32 v228, s51, v228
    v_mov_b32 v165, v164
    v_permlane32_swap_b32 v229, v231
    v_and_b32 v224, s51, v224
    v_permlane16_swap_b32 v164, v165
    v_add_f32 v164, v164, v165
    v_add_f32 v229, v229, v231
    v_permlane32_swap_b32 v228, v230
    v_add_f32_dpp v164, v164, v164 row_ror:8 row_mask:0xf bank_mask:0xf
    v_add_f32 v228, v228, v230
    v_permlane32_swap_b32 v225, v227
    v_add_f32_dpp v164, v164, v164 quad_perm:[1,0,3,2] row_mask:0xf bank_mask:0xf
    v_add_f32 v225, v225, v227
    v_permlane16_swap_b32 v228, v229
    v_add_f32_dpp v164, v164, v164 quad_perm:[2,3,0,1] row_mask:0xf bank_mask:0xf
    v_add_f32 v228, v228, v229
    v_mul_f32 v164, s52, v164
    v_mov_b32 v165, v164
    v_permlane32_swap_b32 v224, v226
    v_add_f32_dpp v25, v228, v228 row_ror:8 row_mask:0xf bank_mask:0xf
    v_permlane32_swap_b32 v164, v165
    v_add_f32 v224, v224, v226
    v_cvt_pk_bf16_f32 v27, v164, v164
    v_and_b32 v27, 0xffff0000, v27
    s_cbranch_vccnz L_slowtail
    v_permlane16_swap_b32 v224, v225
    v_add_f32 v224, v224, v225
    s_nop 1
    v_add_f32_dpp v224, v224, v224 row_ror:8 row_mask:0xf bank_mask:0xf
    v_fma_f32 v224, -v27, v25, v224
    v_cvt_pk_bf16_f32 v224, v224, v224
    ds_write_b16 v11, v224 offset:256
    v_mov_b32 v168, s32
    v_mov_b32 v169, s32
    s_mov_b32 exec_lo, 0xff00ff00
    global_store_dwordx2 v148, v[168:169], s[40:41] sc1
    s_mov_b64 exec, -1
    v_fma_f32 v165, -v164, v164, v165
    v_max_f32 v165, 0, v165
    v_cvt_pk_bf16_f32 v165, v165, v165
    v_and_b32 v165, 0xffff0000, v165
    v_add_f32 v165, s53, v165
    v_cvt_pk_bf16_f32 v165, v165, v165
    v_and_b32 v165, 0xffff0000, v165
    v_sqrt_f32 v165, v165
    s_waitcnt lgkmcnt(0)
    s_barrier
    ds_read_b128 v[176:179], v13 offset:256
    ds_read_b128 v[180:183], v13 offset:320
    ds_read_b128 v[184:187], v13 offset:384
    ds_read_b128 v[188:191], v13 offset:448
    v_cvt_pk_bf16_f32 v165, v165, v165
    v_and_b32 v165, 0xffff0000, v165
    v_rcp_f32 v28, v165
    s_nop 0
    v_mul_f32 v17, s50, v28
    v_mov_b32 v234, s61
    s_waitcnt lgkmcnt(3)
    v_mfma_f32_16x16x32_bf16 v[192:195], v[176:179], v[48:51], 0
    v_mfma_f32_16x16x32_bf16 v[196:199], v[176:179], v[64:67], 0
    s_waitcnt lgkmcnt(2)
    v_mfma_f32_16x16x32_bf16 v[192:195], v[180:183], v[52:55], v[192:195]
    v_mfma_f32_16x16x32_bf16 v[196:199], v[180:183], v[68:71], v[196:199]
    s_waitcnt lgkmcnt(1)
    v_mfma_f32_16x16x32_bf16 v[192:195], v[184:187], v[56:59], v[192:195]
    v_mfma_f32_16x16x32_bf16 v[196:199], v[184:187], v[72:75], v[196:199]
    s_waitcnt lgkmcnt(0)
    v_mfma_f32_16x16x32_bf16 v[192:195], v[188:191], v[60:63], v[192:195]
    v_mfma_f32_16x16x32_bf16 v[196:199], v[188:191], v[76:79], v[196:199]
    ds_read_b64_tr_b16 v[80:81], v20 offset:20480
    ds_read_b64_tr_b16 v[82:83], v20 offset:21504
    ds_read_b64_tr_b16 v[84:85], v20 offset:28672
    ds_read_b64_tr_b16 v[86:87], v20 offset:29696
    ds_read_b64_tr_b16 v[88:89], v20 offset:36864
    ds_read_b64_tr_b16 v[90:91], v20 offset:37888
    ds_read_b64_tr_b16 v[92:93], v20 offset:45056
    ds_read_b64_tr_b16 v[94:95], v20 offset:46080
    v_max_f32 v152, v192, v196
    v_cndmask_b32 v153, v192, v196, s[56:57]
    s_nop 0
    v_max_f32_dpp v152, v152, v152 row_ror:8 row_mask:0xf bank_mask:0xf
    s_nop 1
    v_max_f32_dpp v152, v152, v152 row_ror:4 row_mask:0xf bank_mask:0xf
    s_nop 1
    v_max_f32_dpp v152, v152, v152 row_ror:2 row_mask:0xf bank_mask:0xf
    s_nop 1
    v_max_f32_dpp v152, v152, v152 row_ror:1 row_mask:0xf bank_mask:0xf
    v_mul_f32 v232, v17, v152
    v_fma_f32 v153, v153, v17, -v232
    v_exp_f32 v233, v153
    ds_write_b32 v19, v232 offset:896
    v_cvt_pk_bf16_f32 v153, v233, v233
    ds_write_b16 v4, v153 offset:1024
    ds_read_b64_tr_b16 v[96:97], v21 offset:20480
    ds_read_b64_tr_b16 v[98:99], v21 offset:21504
    ds_read_b64_tr_b16 v[100:101], v21 offset:28672
    ds_read_b64_tr_b16 v[102:103], v21 offset:29696
    ds_read_b64_tr_b16 v[104:105], v21 offset:36864
    ds_read_b64_tr_b16 v[106:107], v21 offset:37888
    ds_read_b64_tr_b16 v[108:109], v21 offset:45056
    ds_read_b64_tr_b16 v[110:111], v21 offset:46080
    v_add_f32_dpp v233, v233, v233 row_ror:8 row_mask:0xf bank_mask:0xf
    s_nop 1
    v_add_f32_dpp v233, v233, v233 row_ror:4 row_mask:0xf bank_mask:0xf
    s_nop 1
    v_add_f32_dpp v233, v233, v233 row_ror:2 row_mask:0xf bank_mask:0xf
    s_waitcnt lgkmcnt(0)
    s_barrier
    ds_read_b32 v156, v29 offset:896
    ds_read_b128 v[176:179], v13 offset:1024
    ds_read_b128 v[180:183], v13 offset:1088
    ds_read_b128 v[184:187], v13 offset:1152
    ds_read_b128 v[188:191], v13 offset:1216
    v_add_f32_dpp v233, v233, v233 row_ror:1 row_mask:0xf bank_mask:0xf
    s_nop 1
    v_add_f32_dpp v233, v233, v233 row_bcast:15 row_mask:0xa bank_mask:0xf
    s_mov_b64 exec, 0x10000
    global_store_dwordx4 v6, v[232:235], s[38:39] offset:512
    s_mov_b64 exec, -1
    s_waitcnt lgkmcnt(3)
    v_mfma_f32_16x16x32_bf16 v[192:195], v[176:179], v[80:83], 0
    v_max_f32_dpp v152, v156, v156 quad_perm:[1,0,3,2] row_mask:0xf bank_mask:0xf
    v_mfma_f32_16x16x32_bf16 v[196:199], v[176:179], v[96:99], 0
    s_waitcnt lgkmcnt(2)
    v_mfma_f32_16x16x32_bf16 v[200:203], v[180:183], v[84:87], 0
    v_max_f32_dpp v152, v152, v152 quad_perm:[2,3,0,1] row_mask:0xf bank_mask:0xf
    v_mfma_f32_16x16x32_bf16 v[204:207], v[180:183], v[100:103], 0
    v_sub_f32 v156, v156, v152
    s_waitcnt lgkmcnt(1)
    v_mfma_f32_16x16x32_bf16 v[208:211], v[184:187], v[88:91], 0
    v_exp_f32 v156, v156
    v_mfma_f32_16x16x32_bf16 v[212:215], v[184:187], v[104:107], 0
    s_waitcnt lgkmcnt(0)
    v_mov_b32_dpp v168, v156 quad_perm:[0,0,0,0] row_mask:0xf bank_mask:0xf
    v_mfma_f32_16x16x32_bf16 v[216:219], v[188:191], v[92:95], 0
    v_mov_b32_dpp v169, v156 quad_perm:[1,1,1,1] row_mask:0xf bank_mask:0xf
    v_mov_b32_dpp v170, v156 quad_perm:[2,2,2,2] row_mask:0xf bank_mask:0xf
    v_mfma_f32_16x16x32_bf16 v[220:223], v[188:191], v[108:111], 0
    global_load_dwordx4 v[248:251], v7, s[38:39] offset:512 sc1
    v_cndmask_b32 v160, v192, v196, s[56:57]
    v_cndmask_b32 v161, v200, v204, s[56:57]
    v_mul_f32 v152, v168, v160
    v_fmac_f32 v152, v169, v161
    v_cndmask_b32 v162, v208, v212, s[56:57]
    v_fmac_f32 v152, v170, v162
    v_mov_b32_dpp v171, v156 quad_perm:[3,3,3,3] row_mask:0xf bank_mask:0xf
    s_mov_b32 exec_hi, 0
    v_cndmask_b32 v163, v216, v220, s[56:57]
    v_fmac_f32 v152, v171, v163
    v_bfi_b32 v152, v8, s61, v152
    global_store_dword v3, v152, s[38:39] offset:2048
    s_mov_b32 exec_hi, -1
    global_load_dwordx4 v[252:255], v7, s[38:39] offset:512 sc1
    s_branch L_rent_3
L_ring_2:
    s_sub_u32 s36, s36, 1
    s_cbranch_scc1 L_end
    global_load_dwordx4 v[248:251], v7, s[38:39] offset:512 sc1
    s_waitcnt vmcnt(1)
    v_cmp_ne_u32 vcc, s61, v254
    v_max_f32_dpp v152, v252, v252 quad_perm:[1,0,3,2] row_mask:0xf bank_mask:0xf
    v_mov_b32 v164, v252
    v_mov_b32 v165, v253
    s_cbranch_vccz L_rdone_4
    global_load_dwordx4 v[252:255], v7, s[38:39] offset:512 sc1
    s_waitcnt vmcnt(1)
L_rent_3:
    s_waitcnt vmcnt(2)
    v_cmp_ne_u32 vcc, s61, v250
    v_max_f32_dpp v152, v248, v248 quad_perm:[1,0,3,2] row_mask:0xf bank_mask:0xf
    v_mov_b32 v164, v248
    v_mov_b32 v165, v249
    s_cbranch_vccnz L_ring_2
L_rdone_4:
    global_load_dwordx4 v[240:243], v2, s[38:39] offset:2048 sc1
    v_max_f32_dpp v152, v152, v152 quad_perm:[2,3,0,1] row_mask:0xf bank_mask:0xf
    s_nop 1
    v_max_f32_dpp v153, v152, v152 row_ror:8 row_mask:0xf bank_mask:0xf
    v_mov_b32 v154, v153
    s_nop 1
    v_permlane16_swap_b32 v153, v154
    v_max_f32 v153, v153, v154
    v_mov_b32 v154, v153
    s_nop 1
    v_permlane32_swap_b32 v153, v154
    v_max_f32 v153, v153, v154
    global_load_dwordx4 v[244:247], v2, s[38:39] offset:2048 sc1
    v_sub_f32 v164, v164, v153
    v_sub_f32 v152, v152, v153
    v_exp_f32 v164, v164
    v_exp_f32 v152, v152
    v_mul_f32 v164, v164, v165
    s_nop 1
    v_add_f32_dpp v164, v164, v164 quad_perm:[1,0,3,2] row_mask:0xf bank_mask:0xf
    s_nop 1
    v_add_f32_dpp v164, v164, v164 quad_perm:[2,3,0,1] row_mask:0xf bank_mask:0xf
    s_nop 1
    v_add_f32_dpp v164, v164, v164 row_ror:8 row_mask:0xf bank_mask:0xf
    v_mov_b32 v154, v164
    s_nop 1
    v_permlane16_swap_b32 v164, v154
    v_add_f32 v164, v164, v154
    v_mov_b32 v154, v164
    s_nop 1
    v_permlane32_swap_b32 v164, v154
    v_add_f32 v164, v164, v154
    v_rcp_f32 v164, v164
    s_nop 0
    v_mul_f32 v30, v152, v164
    s_branch L_rent_6
L_ring_5:
    s_sub_u32 s36, s36, 1
    s_cbranch_scc1 L_end
    global_load_dwordx4 v[240:243], v2, s[38:39] offset:2048 sc1
    s_waitcnt vmcnt(1)
    v_cmp_ne_u32_sdwa vcc, v244, s61 src0_sel:BYTE_0 src1_sel:BYTE_0
    v_and_b32 v244, s51, v244
    v_pk_mul_f32 v[246:247], v[246:247], v[30:31] op_sel_hi:[1,0]
    v_pk_mul_f32 v[244:245], v[244:245], v[30:31] op_sel_hi:[1,0]
    s_nop 1
    v_permlane32_swap_b32 v245, v247
    v_add_f32 v225, v245, v247
    v_permlane32_swap_b32 v244, v246
    v_add_f32 v224, v244, v246
    s_cbranch_vccz L_rdone_7
    global_load_dwordx4 v[244:247], v2, s[38:39] offset:2048 sc1
L_rent_6:
    s_waitcnt vmcnt(1)
    v_cmp_ne_u32_sdwa vcc, v240, s61 src0_sel:BYTE_0 src1_sel:BYTE_0
    v_and_b32 v240, s51, v240
    v_pk_mul_f32 v[242:243], v[242:243], v[30:31] op_sel_hi:[1,0]
    v_pk_mul_f32 v[240:241], v[240:241], v[30:31] op_sel_hi:[1,0]
    s_nop 1
    v_permlane32_swap_b32 v241, v243
    v_add_f32 v225, v241, v243
    v_permlane32_swap_b32 v240, v242
    v_add_f32 v224, v240, v242
    s_cbranch_vccnz L_ring_5
L_rdone_7:
    s_nop 0
    v_permlane16_swap_b32 v224, v225
    v_add_f32 v224, v224, v225
    s_nop 1
    v_add_f32_dpp v224, v224, v224 row_ror:8 row_mask:0xf bank_mask:0xf
    v_cvt_pk_bf16_f32 v224, v224, v224
    ds_write_b16 v11, v224 offset:512
    s_lshl_b32 s59, s28, 11
    s_add_u32 m0, s59, 69632
    s_nop 0
    global_load_lds_dwordx4 v146, s[16:17] offset:0 nt
    global_load_lds_dwordx4 v147, s[16:17] offset:1024 nt
    s_waitcnt lgkmcnt(0)
    s_barrier
    ds_read_b128 v[176:179], v13 offset:512
    ds_read_b64_tr_b16 v[112:113], v22 offset:0
    ds_read_b64_tr_b16 v[114:115], v22 offset:512
    ds_read_b128 v[180:183], v13 offset:576
    ds_read_b64_tr_b16 v[116:117], v22 offset:4096
    ds_read_b64_tr_b16 v[118:119], v22 offset:4608
    ds_read_b128 v[184:187], v13 offset:640
    ds_read_b64_tr_b16 v[120:121], v22 offset:8192
    ds_read_b64_tr_b16 v[122:123], v22 offset:8704
    ds_read_b128 v[188:191], v13 offset:704
    ds_read_b64_tr_b16 v[124:125], v22 offset:12288
    ds_read_b64_tr_b16 v[126:127], v22 offset:12800
    s_waitcnt lgkmcnt(9)
    v_mfma_f32_16x16x32_bf16 v[192:195], v[176:179], v[112:115], 0
    s_waitcnt lgkmcnt(6)
    v_mfma_f32_16x16x32_bf16 v[192:195], v[180:183], v[116:119], v[192:195]
    s_waitcnt lgkmcnt(3)
    v_mfma_f32_16x16x32_bf16 v[192:195], v[184:187], v[120:123], v[192:195]
    s_waitcnt lgkmcnt(0)
    v_mfma_f32_16x16x32_bf16 v[192:195], v[188:191], v[124:127], v[192:195]
    s_mov_b32 exec_hi, 0
    s_nop 6
    v_bfi_b32 v152, v8, s66, v192
    global_store_dword v5, v152, s[40:41] offset:0 sc1
    s_mov_b32 exec_hi, -1
    v_mov_b32 v234, s62
    v_cndmask_b32 v237, v234, v235, s[46:47]
    s_lshl_b32 s59, s28, 11
    s_add_u32 m0, s59, 77824
    s_nop 0
    global_load_lds_dwordx4 v146, s[18:19] offset:0 nt
    global_load_lds_dwordx4 v147, s[18:19] offset:1024 nt
    s_cmp_eq_u32 s28, 3
    s_cbranch_scc1 L_now2_8
    s_min_u32 s59, s28, 2
    s_lshl_b32 s59, s59, 11
    s_add_u32 m0, s59, 86016
    s_nop 0
    global_load_lds_dwordx4 v144, s[20:21] offset:0 nt
    global_load_lds_dwordx4 v145, s[4:5] offset:1024 nt
L_now2_8:
    s_branch L_page_9
.p2align 12
L_page_9:
    s_waitcnt vmcnt(0)
    global_load_dwordx4 v[224:227], v15, s[40:41] offset:0 sc1
    global_load_dwordx4 v[228:231], v15, s[40:41] offset:1024 sc1
    s_branch L_pent_11
L_poll_10:
    s_sub_u32 s36, s36, 1
    s_cbranch_scc1 L_end
    global_load_dwordx4 v[224:227], v15, s[40:41] offset:0 sc1
    global_load_dwordx4 v[228:231], v15, s[40:41] offset:1024 sc1
L_pent_11:
    s_waitcnt vmcnt(0)
    v_bitop3_b32 v175, v224, v228, s66 bitop3:0x7e
    v_cmp_ne_u32_sdwa vcc, v175, v18 src0_sel:BYTE_0 src1_sel:DWORD
    v_pk_add_f32 v[226:227], v[226:227], v[230:231]
    v_add_f32 v225, v225, v229
    v_and_b32 v224, s51, v224
    v_and_b32 v228, s51, v228
    v_add_f32 v224, v224, v228
    v_permlane32_swap_b32 v225, v227
    v_add_f32 v225, v225, v227
    v_permlane32_swap_b32 v224, v226
    v_add_f32 v224, v224, v226
    s_cbranch_vccnz L_poll_10
    s_nop 0
    v_permlane16_swap_b32 v224, v225
    v_add_f32 v224, v224, v225
    s_nop 1
    v_add_f32_dpp v224, v224, v224 row_ror:8 row_mask:0xf bank_mask:0xf
    s_nop 1
    v_add_f32_dpp v224, v224, v224 row_ror:4 row_mask:0xf bank_mask:0xf
    v_cvt_pk_bf16_f32 v224, v224, v224
    v_and_b32 v224, 0xffff0000, v224
    v_add_f32 v224, v224, v24
    v_cvt_pk_bf16_f32 v152, v224, v224
    ds_write_b16 v10, v152 offset:0
    v_and_b32 v236, 0xffff0000, v152
    v_mul_f32 v159, v236, v236
    v_and_b32 v24, 0xffff0000, v152
    s_nop 0
    v_permlane32_swap_b32 v236, v159
    v_add_f32 v236, v236, v159
    s_nop 1
    v_add_f32_dpp v236, v236, v236 quad_perm:[1,0,3,2] row_mask:0xf bank_mask:0xf
    s_nop 1
    v_add_f32_dpp v236, v236, v236 quad_perm:[2,3,0,1] row_mask:0xf bank_mask:0xf
    s_nop 1
    v_add_f32_dpp v236, v236, v236 row_bcast:15 row_mask:0xa bank_mask:0xf
    s_mov_b64 exec, s[42:43]
    global_store_dwordx2 v9, v[236:237], s[38:39] offset:0
    s_mov_b64 exec, -1
    s_cmp_eq_u32 s28, 3
    s_waitcnt lgkmcnt(0)
    s_barrier
    ds_read_b128 v[176:179], v14 offset:0
    ds_read_b64_tr_b16 v[128:129], v22 offset:16384
    ds_read_b64_tr_b16 v[130:131], v22 offset:16896
    ds_read_b64_tr_b16 v[136:137], v22 offset:24576
    ds_read_b64_tr_b16 v[138:139], v22 offset:25088
    ds_read_b128 v[180:183], v14 offset:64
    ds_read_b64_tr_b16 v[132:133], v22 offset:20480
    ds_read_b64_tr_b16 v[134:135], v22 offset:20992
    ds_read_b64_tr_b16 v[140:141], v22 offset:28672
    ds_read_b64_tr_b16 v[142:143], v22 offset:29184
    s_cbranch_scc1 L_idle_12
    s_waitcnt lgkmcnt(7)
    v_mfma_f32_16x16x32_bf16 v[192:195], v[176:179], v[128:131], 0
    s_waitcnt lgkmcnt(5)
    v_mfma_f32_16x16x32_bf16 v[196:199], v[176:179], v[136:139], 0
    global_load_dwordx4 v[248:251], v7, s[38:39] offset:0 sc1
    s_waitcnt lgkmcnt(2)
    v_mfma_f32_16x16x32_bf16 v[192:195], v[180:183], v[132:135], v[192:195]
    s_waitcnt lgkmcnt(0)
    v_mfma_f32_16x16x32_bf16 v[196:199], v[180:183], v[140:143], v[196:199]
    s_nop 7
    v_cndmask_b32 v152, v192, v196, s[56:57]
    v_bfi_b32 v152, v8, s62, v152
    global_store_dword v3, v152, s[38:39] offset:0
    global_load_dwordx4 v[252:255], v7, s[38:39] offset:0 sc1
    s_branch L_rent_14
L_ring_13:
    s_sub_u32 s36, s36, 1
    s_cbranch_scc1 L_end
    global_load_dwordx4 v[248:251], v7, s[38:39] offset:0 sc1
    s_waitcnt vmcnt(1)
    v_cmp_ne_u32 vcc, s62, v253
    v_permlane32_swap_b32 v252, v254
    v_add_f32 v164, v252, v254
    s_cbranch_vccz L_rdone_15
    global_load_dwordx4 v[252:255], v7, s[38:39] offset:0 sc1
    s_waitcnt vmcnt(1)
L_rent_14:
    s_waitcnt vmcnt(2)
    v_cmp_ne_u32 vcc, s62, v249
    v_permlane32_swap_b32 v248, v250
    v_add_f32 v164, v248, v250
    s_cbranch_vccnz L_ring_13
L_rdone_15:
    global_load_dwordx4 v[240:243], v2, s[38:39] offset:0 sc1
    global_load_dwordx4 v[208:211], v2, s[38:39] offset:1024 sc1
    v_mov_b32 v165, v164
    s_nop 1
    v_permlane16_swap_b32 v164, v165
    v_add_f32 v164, v164, v165
    s_nop 1
    v_add_f32_dpp v164, v164, v164 row_ror:8 row_mask:0xf bank_mask:0xf
    s_nop 1
    v_add_f32_dpp v164, v164, v164 quad_perm:[1,0,3,2] row_mask:0xf bank_mask:0xf
    s_nop 1
    v_add_f32_dpp v164, v164, v164 quad_perm:[2,3,0,1] row_mask:0xf bank_mask:0xf
    v_mul_f32 v164, s52, v164
    v_mov_b32 v165, v164
    s_nop 1
    v_permlane32_swap_b32 v164, v165
    v_cvt_pk_bf16_f32 v27, v164, v164
    v_and_b32 v27, 0xffff0000, v27
    global_load_dwordx4 v[244:247], v2, s[38:39] offset:0 sc1
    global_load_dwordx4 v[212:215], v2, s[38:39] offset:1024 sc1
    v_fma_f32 v165, -v164, v164, v165
    v_max_f32 v165, 0, v165
    v_cvt_pk_bf16_f32 v165, v165, v165
    v_and_b32 v165, 0xffff0000, v165
    v_add_f32 v165, s53, v165
    v_cvt_pk_bf16_f32 v165, v165, v165
    v_and_b32 v165, 0xffff0000, v165
    v_sqrt_f32 v165, v165
    s_nop 0
    v_cvt_pk_bf16_f32 v165, v165, v165
    v_and_b32 v165, 0xffff0000, v165
    v_rcp_f32 v28, v165
    v_and_b32 v153, 32, v1
    v_lshlrev_b32 v153, 6, v153
    v_sub_u32 v153, v22, v153
    ds_read_b64_tr_b16 v[144:145], v22 offset:32768
    ds_read_b64_tr_b16 v[146:147], v22 offset:33280
    ds_read_b64_tr_b16 v[148:149], v153 offset:36864
    ds_read_b64_tr_b16 v[150:151], v153 offset:37376
    s_branch L_rent_17
L_ring_16:
    s_sub_u32 s36, s36, 1
    s_cbranch_scc1 L_end
    global_load_dwordx4 v[240:243], v2, s[38:39] offset:0 sc1
    global_load_dwordx4 v[208:211], v2, s[38:39] offset:1024 sc1
    s_waitcnt vmcnt(2)
    v_bitop3_b32 v175, v244, v212, s62 bitop3:0x7e
    v_cmp_ne_u32_sdwa vcc, v175, v18 src0_sel:BYTE_0 src1_sel:DWORD
    v_and_b32 v244, s51, v244
    v_and_b32 v212, s51, v212
    v_permlane32_swap_b32 v245, v247
    v_permlane32_swap_b32 v213, v215
    v_add_f32 v225, v245, v247
    v_add_f32 v229, v213, v215
    v_permlane32_swap_b32 v244, v246
    v_permlane32_swap_b32 v212, v214
    v_add_f32 v228, v212, v214
    v_add_f32 v224, v244, v246
    s_cbranch_vccz L_rdone_18
    global_load_dwordx4 v[244:247], v2, s[38:39] offset:0 sc1
    global_load_dwordx4 v[212:215], v2, s[38:39] offset:1024 sc1
L_rent_17:
    s_waitcnt vmcnt(2)
    v_bitop3_b32 v175, v240, v208, s62 bitop3:0x7e
    v_cmp_ne_u32_sdwa vcc, v175, v18 src0_sel:BYTE_0 src1_sel:DWORD
    v_and_b32 v240, s51, v240
    v_and_b32 v208, s51, v208
    v_permlane32_swap_b32 v241, v243
    v_permlane32_swap_b32 v209, v211
    v_add_f32 v225, v241, v243
    v_add_f32 v229, v209, v211
    v_permlane32_swap_b32 v240, v242
    v_permlane32_swap_b32 v208, v210
    v_add_f32 v228, v208, v210
    v_add_f32 v224, v240, v242
    s_cbranch_vccnz L_ring_16
L_rdone_18:
    v_permlane16_swap_b32 v228, v229
    v_add_f32 v228, v228, v229
    v_permlane16_swap_b32 v224, v225
    v_add_f32 v224, v224, v225
    v_add_f32_dpp v26, v228, v228 row_ror:8 row_mask:0xf bank_mask:0xf
    s_nop 0
    v_add_f32_dpp v224, v224, v224 row_ror:8 row_mask:0xf bank_mask:0xf
    v_fma_f32 v224, -v27, v26, v224
    v_mul_f32 v224, v224, v28
    v_cvt_pk_bf16_f32 v224, v224, v224
    v_and_b32 v224, 0xffff0000, v224
    v_mul_f32 v225, s54, v224
    v_exp_f32 v225, v225
    v_and_b32_dpp v226, v224, v23 row_shl:4 row_mask:0xf bank_mask:0xf
    v_add_f32 v225, 1.0, v225
    v_rcp_f32 v225, v225
    s_nop 0
    v_mul_f32 v224, v224, v225
    v_cvt_pk_bf16_f32 v224, v224, v224
    v_and_b32 v224, 0xffff0000, v224
    v_mul_f32 v224, v224, v226
    v_cvt_pk_bf16_f32 v224, v224, v224
    ds_write_b16 v12, v224
L_join_19:
    s_waitcnt lgkmcnt(0)
    s_barrier
    ds_read_b128 v[176:179], v13 offset:768
    ds_read_b128 v[180:183], v13 offset:832
    s_not_b32 s4, s66
    s_xor_b32 s5, s31, 8192
    v_mov_b32 v156, s31
    s_waitcnt lgkmcnt(1)
    v_mfma_f32_16x16x32_bf16 v[192:195], v[176:179], v[144:147], 0
    s_waitcnt lgkmcnt(0)
    v_mfma_f32_16x16x32_bf16 v[192:195], v[180:183], v[148:151], v[192:195]
    global_load_dword v157, v156, s[26:27] sc1
    s_load_dword s4, s[26:27], s5
    s_mov_b32 exec_hi, 0
    s_nop 4
    v_bfi_b32 v152, v8, s67, v192
    global_store_dword v5, v152, s[40:41] offset:2048 sc1
    s_mov_b32 exec_hi, -1
    v_mov_b32 v234, s63
    v_cndmask_b32 v237, v234, v235, s[46:47]
    s_lshr_b32 s55, s28, 1
    s_xor_b32 s59, s55, 1
    s_mul_i32 s55, s55, 0x22000
    s_mul_i32 s59, s59, 0x22000
    s_not_b32 s6, s66
    s_waitcnt vmcnt(1)
    s_cmp_lg_u32 s4, s6
    s_cselect_b32 s55, s59, s55
    v_xor_b32 v15, s55, v16
    s_branch L_skip_20
L_idle_12:
    v_and_b32 v153, 32, v1
    v_lshlrev_b32 v153, 6, v153
    v_sub_u32 v153, v22, v153
    ds_read_b64_tr_b16 v[144:145], v22 offset:32768
    ds_read_b64_tr_b16 v[146:147], v22 offset:33280
    ds_read_b64_tr_b16 v[148:149], v153 offset:36864
    ds_read_b64_tr_b16 v[150:151], v153 offset:37376
    s_cmp_lg_u32 s2, 255
    s_cbranch_scc1 L_join_19
    s_add_u32 s55, s32, 16
    v_mov_b32 v154, s55
    v_lshlrev_b32 v155, 2, v1
    s_mov_b32 exec_hi, 0
    global_store_dword v155, v154, s[26:27]
    s_mov_b64 exec, -1
    s_branch L_join_19
L_skip_20:
    s_waitcnt vmcnt(0)
    global_load_dwordx4 v[224:227], v15, s[40:41] offset:2048 sc1
    global_load_dwordx4 v[228:231], v15, s[40:41] offset:3072 sc1
    s_branch L_pent_22
L_poll_21:
    s_sub_u32 s36, s36, 1
    s_cbranch_scc1 L_end
    global_load_dwordx4 v[224:227], v15, s[40:41] offset:2048 sc1
    global_load_dwordx4 v[228:231], v15, s[40:41] offset:3072 sc1
L_pent_22:
    s_waitcnt vmcnt(0)
    v_bitop3_b32 v175, v224, v228, s67 bitop3:0x7e
    v_cmp_ne_u32_sdwa vcc, v175, v18 src0_sel:BYTE_0 src1_sel:DWORD
    v_pk_add_f32 v[226:227], v[226:227], v[230:231]
    v_add_f32 v225, v225, v229
    v_and_b32 v224, s51, v224
    v_and_b32 v228, s51, v228
    v_add_f32 v224, v224, v228
    v_permlane32_swap_b32 v225, v227
    v_add_f32 v225, v225, v227
    v_permlane32_swap_b32 v224, v226
    v_add_f32 v224, v224, v226
    s_cbranch_vccnz L_poll_21
    s_nop 0
    v_permlane16_swap_b32 v224, v225
    v_add_f32 v224, v224, v225
    s_nop 1
    v_add_f32_dpp v224, v224, v224 row_ror:8 row_mask:0xf bank_mask:0xf
    s_nop 1
    v_add_f32_dpp v224, v224, v224 row_ror:4 row_mask:0xf bank_mask:0xf
    v_cvt_pk_bf16_f32 v224, v224, v224
    v_and_b32 v224, 0xffff0000, v224
    v_add_f32 v224, v224, v24
    v_cvt_pk_bf16_f32 v152, v224, v224
    ds_write_b16 v10, v152 offset:0
    v_and_b32 v236, 0xffff0000, v152
    v_mul_f32 v159, v236, v236
    v_and_b32 v24, 0xffff0000, v152
    s_nop 0
    v_permlane32_swap_b32 v236, v159
    v_add_f32 v236, v236, v159
    s_nop 1
    v_add_f32_dpp v236, v236, v236 quad_perm:[1,0,3,2] row_mask:0xf bank_mask:0xf
    s_nop 1
    v_add_f32_dpp v236, v236, v236 quad_perm:[2,3,0,1] row_mask:0xf bank_mask:0xf
    s_nop 1
    v_add_f32_dpp v236, v236, v236 row_bcast:15 row_mask:0xa bank_mask:0xf
    s_mov_b64 exec, s[42:43]
    global_store_dwordx2 v9, v[236:237], s[38:39] offset:512
    s_mov_b64 exec, -1
    s_waitcnt lgkmcnt(0)
    s_barrier
    ds_read_b128 v[176:179], v13 offset:0
    ds_read_b128 v[180:183], v13 offset:64
    s_waitcnt lgkmcnt(1)
    v_mfma_f32_16x16x32_bf16 v[192:195], v[176:179], v[32:35], 0
    v_mfma_f32_16x16x32_bf16 v[196:199], v[176:179], v[40:43], 0
    global_load_dwordx4 v[248:251], v7, s[38:39] offset:512 sc1
    s_waitcnt lgkmcnt(0)
    v_mfma_f32_16x16x32_bf16 v[192:195], v[180:183], v[36:39], v[192:195]
    v_mfma_f32_16x16x32_bf16 v[196:199], v[180:183], v[44:47], v[196:199]
    s_mov_b32 exec_hi, 0
    s_nop 6
    v_cndmask_b32 v152, v192, v196, s[56:57]
    v_bfi_b32 v152, v8, s63, v152
    global_store_dword v3, v152, s[38:39] offset:2048
    s_mov_b32 exec_hi, -1
    global_load_dwordx4 v[252:255], v7, s[38:39] offset:512 sc1
    s_branch L_rent_24
L_ring_23:
    s_sub_u32 s36, s36, 1
    s_cbranch_scc1 L_end
    global_load_dwordx4 v[248:251], v7, s[38:39] offset:512 sc1
    s_waitcnt vmcnt(1)
    v_cmp_ne_u32 vcc, s63, v253
    v_permlane32_swap_b32 v252, v254
    v_add_f32 v164, v252, v254
    s_cbranch_vccz L_rdone_25
    global_load_dwordx4 v[252:255], v7, s[38:39] offset:512 sc1
    s_waitcnt vmcnt(1)
L_rent_24:
    s_waitcnt vmcnt(2)
    v_cmp_ne_u32 vcc, s63, v249
    v_permlane32_swap_b32 v248, v250
    v_add_f32 v164, v248, v250
    s_cbranch_vccnz L_ring_23
L_rdone_25:
    global_load_dwordx4 v[240:243], v2, s[38:39] offset:2048 sc1
    v_mov_b32 v165, v164
    s_nop 1
    v_permlane16_swap_b32 v164, v165
    v_add_f32 v164, v164, v165
    s_nop 1
    v_add_f32_dpp v164, v164, v164 row_ror:8 row_mask:0xf bank_mask:0xf
    s_nop 1
    v_add_f32_dpp v164, v164, v164 quad_perm:[1,0,3,2] row_mask:0xf bank_mask:0xf
    s_nop 1
    v_add_f32_dpp v164, v164, v164 quad_perm:[2,3,0,1] row_mask:0xf bank_mask:0xf
    v_mul_f32 v164, s52, v164
    v_mov_b32 v165, v164
    s_nop 1
    v_permlane32_swap_b32 v164, v165
    v_cvt_pk_bf16_f32 v27, v164, v164
    v_and_b32 v27, 0xffff0000, v27
    global_load_dwordx4 v[244:247], v2, s[38:39] offset:2048 sc1
    s_branch L_rent_27
L_ring_26:
    s_sub_u32 s36, s36, 1
    s_cbranch_scc1 L_end
    global_load_dwordx4 v[240:243], v2, s[38:39] offset:2048 sc1
    s_waitcnt vmcnt(1)
    v_cmp_ne_u32_sdwa vcc, v244, s63 src0_sel:BYTE_0 src1_sel:BYTE_0
    v_and_b32 v244, s51, v244
    v_permlane32_swap_b32 v245, v247
    v_add_f32 v225, v245, v247
    v_permlane32_swap_b32 v244, v246
    v_add_f32 v224, v244, v246
    s_cbranch_vccz L_rdone_28
    global_load_dwordx4 v[244:247], v2, s[38:39] offset:2048 sc1
L_rent_27:
    s_waitcnt vmcnt(1)
    v_cmp_ne_u32_sdwa vcc, v240, s63 src0_sel:BYTE_0 src1_sel:BYTE_0
    v_and_b32 v240, s51, v240
    v_permlane32_swap_b32 v241, v243
    v_add_f32 v225, v241, v243
    v_permlane32_swap_b32 v240, v242
    v_add_f32 v224, v240, v242
    s_cbranch_vccnz L_ring_26
L_rdone_28:
    s_nop 0
    v_permlane16_swap_b32 v224, v225
    v_add_f32 v224, v224, v225
    s_nop 1
    v_add_f32_dpp v224, v224, v224 row_ror:8 row_mask:0xf bank_mask:0xf
    v_fma_f32 v224, -v27, v25, v224
    v_cvt_pk_bf16_f32 v224, v224, v224
    ds_write_b16 v11, v224 offset:256
    v_fma_f32 v165, -v164, v164, v165
    v_max_f32 v165, 0, v165
    v_cvt_pk_bf16_f32 v165, v165, v165
    v_and_b32 v165, 0xffff0000, v165
    v_add_f32 v165, s53, v165
    v_cvt_pk_bf16_f32 v165, v165, v165
    v_and_b32 v165, 0xffff0000, v165
    v_sqrt_f32 v165, v165
    s_waitcnt lgkmcnt(0)
    s_barrier
    ds_read_b128 v[176:179], v13 offset:256
    ds_read_b128 v[180:183], v13 offset:320
    ds_read_b128 v[184:187], v13 offset:384
    ds_read_b128 v[188:191], v13 offset:448
    v_cvt_pk_bf16_f32 v165, v165, v165
    v_and_b32 v165, 0xffff0000, v165
    v_rcp_f32 v28, v165
    s_nop 0
    v_mul_f32 v17, s50, v28
    v_mov_b32 v234, s64
    s_waitcnt lgkmcnt(3)
    v_mfma_f32_16x16x32_bf16 v[192:195], v[176:179], v[48:51], 0
    v_mfma_f32_16x16x32_bf16 v[196:199], v[176:179], v[64:67], 0
    s_waitcnt lgkmcnt(2)
    v_mfma_f32_16x16x32_bf16 v[192:195], v[180:183], v[52:55], v[192:195]
    v_mfma_f32_16x16x32_bf16 v[196:199], v[180:183], v[68:71], v[196:199]
    s_waitcnt lgkmcnt(1)
    v_mfma_f32_16x16x32_bf16 v[192:195], v[184:187], v[56:59], v[192:195]
    v_mfma_f32_16x16x32_bf16 v[196:199], v[184:187], v[72:75], v[196:199]
    s_waitcnt lgkmcnt(0)
    v_mfma_f32_16x16x32_bf16 v[192:195], v[188:191], v[60:63], v[192:195]
    v_mfma_f32_16x16x32_bf16 v[196:199], v[188:191], v[76:79], v[196:199]
    s_nop 7
    v_max_f32 v152, v192, v196
    v_cndmask_b32 v153, v192, v196, s[56:57]
    s_nop 0
    v_max_f32_dpp v152, v152, v152 row_ror:8 row_mask:0xf bank_mask:0xf
    s_nop 1
    v_max_f32_dpp v152, v152, v152 row_ror:4 row_mask:0xf bank_mask:0xf
    s_nop 1
    v_max_f32_dpp v152, v152, v152 row_ror:2 row_mask:0xf bank_mask:0xf
    s_nop 1
    v_max_f32_dpp v152, v152, v152 row_ror:1 row_mask:0xf bank_mask:0xf
    v_mul_f32 v232, v17, v152
    v_fma_f32 v153, v153, v17, -v232
    v_exp_f32 v233, v153
    ds_write_b32 v19, v232 offset:896
    v_cvt_pk_bf16_f32 v153, v233, v233
    ds_write_b16 v4, v153 offset:1024
    v_add_f32_dpp v233, v233, v233 row_ror:8 row_mask:0xf bank_mask:0xf
    s_nop 1
    v_add_f32_dpp v233, v233, v233 row_ror:4 row_mask:0xf bank_mask:0xf
    s_nop 1
    v_add_f32_dpp v233, v233, v233 row_ror:2 row_mask:0xf bank_mask:0xf
    s_waitcnt lgkmcnt(0)
    s_barrier
    ds_read_b32 v156, v29 offset:896
    ds_read_b128 v[176:179], v13 offset:1024
    ds_read_b128 v[180:183], v13 offset:1088
    ds_read_b128 v[184:187], v13 offset:1152
    ds_read_b128 v[188:191], v13 offset:1216
    v_add_f32_dpp v233, v233, v233 row_ror:1 row_mask:0xf bank_mask:0xf
    s_nop 1
    v_add_f32_dpp v233, v233, v233 row_bcast:15 row_mask:0xa bank_mask:0xf
    s_mov_b64 exec, 0x10000
    global_store_dwordx4 v6, v[232:235], s[38:39] offset:0
    s_mov_b64 exec, -1
    s_waitcnt lgkmcnt(3)
    v_mfma_f32_16x16x32_bf16 v[192:195], v[176:179], v[80:83], 0
    v_max_f32_dpp v152, v156, v156 quad_perm:[1,0,3,2] row_mask:0xf bank_mask:0xf
    v_mfma_f32_16x16x32_bf16 v[196:199], v[176:179], v[96:99], 0
    s_waitcnt lgkmcnt(2)
    v_mfma_f32_16x16x32_bf16 v[200:203], v[180:183], v[84:87], 0
    v_max_f32_dpp v152, v152, v152 quad_perm:[2,3,0,1] row_mask:0xf bank_mask:0xf
    v_mfma_f32_16x16x32_bf16 v[204:207], v[180:183], v[100:103], 0
    v_sub_f32 v156, v156, v152
    s_waitcnt lgkmcnt(1)
    v_mfma_f32_16x16x32_bf16 v[208:211], v[184:187], v[88:91], 0
    v_exp_f32 v156, v156
    v_mfma_f32_16x16x32_bf16 v[212:215], v[184:187], v[104:107], 0
    s_waitcnt lgkmcnt(0)
    v_mov_b32_dpp v168, v156 quad_perm:[0,0,0,0] row_mask:0xf bank_mask:0xf
    v_mfma_f32_16x16x32_bf16 v[216:219], v[188:191], v[92:95], 0
    v_mov_b32_dpp v169, v156 quad_perm:[1,1,1,1] row_mask:0xf bank_mask:0xf
    v_mov_b32_dpp v170, v156 quad_perm:[2,2,2,2] row_mask:0xf bank_mask:0xf
    v_mfma_f32_16x16x32_bf16 v[220:223], v[188:191], v[108:111], 0
    global_load_dwordx4 v[248:251], v7, s[38:39] offset:0 sc1
    v_cndmask_b32 v160, v192, v196, s[56:57]
    v_cndmask_b32 v161, v200, v204, s[56:57]
    v_mul_f32 v152, v168, v160
    v_fmac_f32 v152, v169, v161
    v_cndmask_b32 v162, v208, v212, s[56:57]
    v_fmac_f32 v152, v170, v162
    v_mov_b32_dpp v171, v156 quad_perm:[3,3,3,3] row_mask:0xf bank_mask:0xf
    s_mov_b32 exec_hi, 0
    v_cndmask_b32 v163, v216, v220, s[56:57]
    v_fmac_f32 v152, v171, v163
    v_bfi_b32 v152, v8, s64, v152
    global_store_dword v3, v152, s[38:39] offset:0
    s_mov_b32 exec_hi, -1
    global_load_dwordx4 v[252:255], v7, s[38:39] offset:0 sc1
    s_branch L_rent_30
L_ring_29:
    s_sub_u32 s36, s36, 1
    s_cbranch_scc1 L_end
    global_load_dwordx4 v[248:251], v7, s[38:39] offset:0 sc1
    s_waitcnt vmcnt(1)
    v_cmp_ne_u32 vcc, s64, v254
    v_max_f32_dpp v152, v252, v252 quad_perm:[1,0,3,2] row_mask:0xf bank_mask:0xf
    v_mov_b32 v164, v252
    v_mov_b32 v165, v253
    s_cbranch_vccz L_rdone_31
    global_load_dwordx4 v[252:255], v7, s[38:39] offset:0 sc1
    s_waitcnt vmcnt(1)
L_rent_30:
    s_waitcnt vmcnt(2)
    v_cmp_ne_u32 vcc, s64, v250
    v_max_f32_dpp v152, v248, v248 quad_perm:[1,0,3,2] row_mask:0xf bank_mask:0xf
    v_mov_b32 v164, v248
    v_mov_b32 v165, v249
    s_cbranch_vccnz L_ring_29
L_rdone_31:
    global_load_dwordx4 v[240:243], v2, s[38:39] offset:0 sc1
    v_max_f32_dpp v152, v152, v152 quad_perm:[2,3,0,1] row_mask:0xf bank_mask:0xf
    s_nop 1
    v_max_f32_dpp v153, v152, v152 row_ror:8 row_mask:0xf bank_mask:0xf
    v_mov_b32 v154, v153
    s_nop 1
    v_permlane16_swap_b32 v153, v154
    v_max_f32 v153, v153, v154
    v_mov_b32 v154, v153
    s_nop 1
    v_permlane32_swap_b32 v153, v154
    v_max_f32 v153, v153, v154
    global_load_dwordx4 v[244:247], v2, s[38:39] offset:0 sc1
    v_sub_f32 v164, v164, v153
    v_sub_f32 v152, v152, v153
    v_exp_f32 v164, v164
    v_exp_f32 v152, v152
    v_mul_f32 v164, v164, v165
    s_nop 1
    v_add_f32_dpp v164, v164, v164 quad_perm:[1,0,3,2] row_mask:0xf bank_mask:0xf
    s_nop 1
    v_add_f32_dpp v164, v164, v164 quad_perm:[2,3,0,1] row_mask:0xf bank_mask:0xf
    s_nop 1
    v_add_f32_dpp v164, v164, v164 row_ror:8 row_mask:0xf bank_mask:0xf
    v_mov_b32 v154, v164
    s_nop 1
    v_permlane16_swap_b32 v164, v154
    v_add_f32 v164, v164, v154
    v_mov_b32 v154, v164
    s_nop 1
    v_permlane32_swap_b32 v164, v154
    v_add_f32 v164, v164, v154
    v_rcp_f32 v164, v164
    s_nop 0
    v_mul_f32 v30, v152, v164
    s_branch L_rent_33
L_ring_32:
    s_sub_u32 s36, s36, 1
    s_cbranch_scc1 L_end
    global_load_dwordx4 v[240:243], v2, s[38:39] offset:0 sc1
    s_waitcnt vmcnt(1)
    v_cmp_ne_u32_sdwa vcc, v244, s64 src0_sel:BYTE_0 src1_sel:BYTE_0
    v_and_b32 v244, s51, v244
    v_pk_mul_f32 v[246:247], v[246:247], v[30:31] op_sel_hi:[1,0]
    v_pk_mul_f32 v[244:245], v[244:245], v[30:31] op_sel_hi:[1,0]
    s_nop 1
    v_permlane32_swap_b32 v245, v247
    v_add_f32 v225, v245, v247
    v_permlane32_swap_b32 v244, v246
    v_add_f32 v224, v244, v246
    s_cbranch_vccz L_rdone_34
    global_load_dwordx4 v[244:247], v2, s[38:39] offset:0 sc1
L_rent_33:
    s_waitcnt vmcnt(1)
    v_cmp_ne_u32_sdwa vcc, v240, s64 src0_sel:BYTE_0 src1_sel:BYTE_0
    v_and_b32 v240, s51, v240
    v_pk_mul_f32 v[242:243], v[242:243], v[30:31] op_sel_hi:[1,0]
    v_pk_mul_f32 v[240:241], v[240:241], v[30:31] op_sel_hi:[1,0]
    s_nop 1
    v_permlane32_swap_b32 v241, v243
    v_add_f32 v225, v241, v243
    v_permlane32_swap_b32 v240, v242
    v_add_f32 v224, v240, v242
    s_cbranch_vccnz L_ring_32
L_rdone_34:
    s_nop 0
    v_permlane16_swap_b32 v224, v225
    v_add_f32 v224, v224, v225
    s_nop 1
    v_add_f32_dpp v224, v224, v224 row_ror:8 row_mask:0xf bank_mask:0xf
    v_cvt_pk_bf16_f32 v224, v224, v224
    ds_write_b16 v11, v224 offset:512
    s_waitcnt lgkmcnt(0)
    s_barrier
    ds_read_b128 v[176:179], v13 offset:512
    ds_read_b128 v[180:183], v13 offset:576
    ds_read_b128 v[184:187], v13 offset:640
    ds_read_b128 v[188:191], v13 offset:704
    s_waitcnt lgkmcnt(3)
    v_mfma_f32_16x16x32_bf16 v[192:195], v[176:179], v[112:115], 0
    s_waitcnt lgkmcnt(2)
    v_mfma_f32_16x16x32_bf16 v[192:195], v[180:183], v[116:119], v[192:195]
    s_waitcnt lgkmcnt(1)
    v_mfma_f32_16x16x32_bf16 v[192:195], v[184:187], v[120:123], v[192:195]
    s_waitcnt lgkmcnt(0)
    v_mfma_f32_16x16x32_bf16 v[192:195], v[188:191], v[124:127], v[192:195]
    s_mov_b32 exec_hi, 0
    s_nop 6
    v_bfi_b32 v152, v8, s68, v192
    global_store_dword v5, v152, s[14:15] offset:0 sc1
    s_mov_b32 exec_hi, -1
    v_mov_b32 v234, s65
    v_cndmask_b32 v237, v234, v235, s[46:47]
    s_branch L_page_35
.p2align 12
L_page_35:
    s_waitcnt vmcnt(0)
    global_load_dwordx4 v[224:227], v15, s[14:15] offset:0 sc1
    global_load_dwordx4 v[228:231], v15, s[14:15] offset:1024 sc1
    s_branch L_pent_37
L_poll_36:
    s_sub_u32 s36, s36, 1
    s_cbranch_scc1 L_end
    global_load_dwordx4 v[224:227], v15, s[14:15] offset:0 sc1
    global_load_dwordx4 v[228:231], v15, s[14:15] offset:1024 sc1
L_pent_37:
    s_waitcnt vmcnt(0)
    v_bitop3_b32 v175, v224, v228, s68 bitop3:0x7e
    v_cmp_ne_u32_sdwa vcc, v175, v18 src0_sel:BYTE_0 src1_sel:DWORD
    v_pk_add_f32 v[226:227], v[226:227], v[230:231]
    v_add_f32 v225, v225, v229
    v_and_b32 v224, s51, v224
    v_and_b32 v228, s51, v228
    v_add_f32 v224, v224, v228
    v_permlane32_swap_b32 v225, v227
    v_add_f32 v225, v225, v227
    v_permlane32_swap_b32 v224, v226
    v_add_f32 v224, v224, v226
    s_cbranch_vccnz L_poll_36
    s_nop 0
    v_permlane16_swap_b32 v224, v225
    v_add_f32 v224, v224, v225
    s_nop 1
    v_add_f32_dpp v224, v224, v224 row_ror:8 row_mask:0xf bank_mask:0xf
    s_nop 1
    v_add_f32_dpp v224, v224, v224 row_ror:4 row_mask:0xf bank_mask:0xf
    v_cvt_pk_bf16_f32 v224, v224, v224
    v_and_b32 v224, 0xffff0000, v224
    v_add_f32 v224, v224, v24
    v_cvt_pk_bf16_f32 v152, v224, v224
    ds_write_b16 v10, v152 offset:0
    v_and_b32 v236, 0xffff0000, v152
    v_mul_f32 v159, v236, v236
    v_and_b32 v24, 0xffff0000, v152
    s_nop 0
    v_permlane32_swap_b32 v236, v159
    v_add_f32 v236, v236, v159
    s_nop 1
    v_add_f32_dpp v236, v236, v236 quad_perm:[1,0,3,2] row_mask:0xf bank_mask:0xf
    s_nop 1
    v_add_f32_dpp v236, v236, v236 quad_perm:[2,3,0,1] row_mask:0xf bank_mask:0xf
    s_nop 1
    v_add_f32_dpp v236, v236, v236 row_bcast:15 row_mask:0xa bank_mask:0xf
    s_mov_b64 exec, s[42:43]
    global_store_dwordx2 v9, v[236:237], s[38:39] offset:512
    s_mov_b64 exec, -1
    s_cmp_eq_u32 s28, 3
    s_waitcnt lgkmcnt(0)
    s_barrier
    ds_read_b128 v[176:179], v13 offset:0
    ds_read_b128 v[180:183], v13 offset:64
    s_cbranch_scc1 L_idle_38
    s_waitcnt lgkmcnt(1)
    v_mfma_f32_16x16x32_bf16 v[192:195], v[176:179], v[128:131], 0
    v_mfma_f32_16x16x32_bf16 v[196:199], v[176:179], v[136:139], 0
    global_load_dwordx4 v[248:251], v7, s[38:39] offset:512 sc1
    s_waitcnt lgkmcnt(0)
    v_mfma_f32_16x16x32_bf16 v[192:195], v[180:183], v[132:135], v[192:195]
    v_mfma_f32_16x16x32_bf16 v[196:199], v[180:183], v[140:143], v[196:199]
    s_mov_b32 exec_hi, 0
    s_nop 6
    v_cndmask_b32 v152, v192, v196, s[56:57]
    v_bfi_b32 v152, v8, s65, v152
    global_store_dword v3, v152, s[38:39] offset:2048
    s_mov_b32 exec_hi, -1
    global_load_dwordx4 v[252:255], v7, s[38:39] offset:512 sc1
    s_branch L_rent_40
L_ring_39:
    s_sub_u32 s36, s36, 1
    s_cbranch_scc1 L_end
    global_load_dwordx4 v[248:251], v7, s[38:39] offset:512 sc1
    s_waitcnt vmcnt(1)
    v_cmp_ne_u32 vcc, s65, v253
    v_permlane32_swap_b32 v252, v254
    v_add_f32 v164, v252, v254
    s_cbranch_vccz L_rdone_41
    global_load_dwordx4 v[252:255], v7, s[38:39] offset:512 sc1
    s_waitcnt vmcnt(1)
L_rent_40:
    s_waitcnt vmcnt(2)
    v_cmp_ne_u32 vcc, s65, v249
    v_permlane32_swap_b32 v248, v250
    v_add_f32 v164, v248, v250
    s_cbranch_vccnz L_ring_39
L_rdone_41:
    global_load_dwordx4 v[240:243], v2, s[38:39] offset:2048 sc1
    v_mov_b32 v165, v164
    s_nop 1
    v_permlane16_swap_b32 v164, v165
    v_add_f32 v164, v164, v165
    s_nop 1
    v_add_f32_dpp v164, v164, v164 row_ror:8 row_mask:0xf bank_mask:0xf
    s_nop 1
    v_add_f32_dpp v164, v164, v164 quad_perm:[1,0,3,2] row_mask:0xf bank_mask:0xf
    s_nop 1
    v_add_f32_dpp v164, v164, v164 quad_perm:[2,3,0,1] row_mask:0xf bank_mask:0xf
    v_mul_f32 v164, s52, v164
    v_mov_b32 v165, v164
    s_nop 1
    v_permlane32_swap_b32 v164, v165
    v_cvt_pk_bf16_f32 v27, v164, v164
    v_and_b32 v27, 0xffff0000, v27
    global_load_dwordx4 v[244:247], v2, s[38:39] offset:2048 sc1
    v_fma_f32 v165, -v164, v164, v165
    v_max_f32 v165, 0, v165
    v_cvt_pk_bf16_f32 v165, v165, v165
    v_and_b32 v165, 0xffff0000, v165
    v_add_f32 v165, s53, v165
    v_cvt_pk_bf16_f32 v165, v165, v165
    v_and_b32 v165, 0xffff0000, v165
    v_sqrt_f32 v165, v165
    s_nop 0
    v_cvt_pk_bf16_f32 v165, v165, v165
    v_and_b32 v165, 0xffff0000, v165
    v_rcp_f32 v28, v165
    s_branch L_rent_43
L_ring_42:
    s_sub_u32 s36, s36, 1
    s_cbranch_scc1 L_end
    global_load_dwordx4 v[240:243], v2, s[38:39] offset:2048 sc1
    s_waitcnt vmcnt(1)
    v_cmp_ne_u32_sdwa vcc, v244, s65 src0_sel:BYTE_0 src1_sel:BYTE_0
    v_and_b32 v244, s51, v244
    v_permlane32_swap_b32 v245, v247
    v_add_f32 v225, v245, v247
    v_permlane32_swap_b32 v244, v246
    v_add_f32 v224, v244, v246
    s_cbranch_vccz L_rdone_44
    global_load_dwordx4 v[244:247], v2, s[38:39] offset:2048 sc1
L_rent_43:
    s_waitcnt vmcnt(1)
    v_cmp_ne_u32_sdwa vcc, v240, s65 src0_sel:BYTE_0 src1_sel:BYTE_0
    v_and_b32 v240, s51, v240
    v_permlane32_swap_b32 v241, v243
    v_add_f32 v225, v241, v243
    v_permlane32_swap_b32 v240, v242
    v_add_f32 v224, v240, v242
    s_cbranch_vccnz L_ring_42
L_rdone_44:
    s_nop 0
    v_permlane16_swap_b32 v224, v225
    v_add_f32 v224, v224, v225
    s_nop 1
    v_add_f32_dpp v224, v224, v224 row_ror:8 row_mask:0xf bank_mask:0xf
    v_fma_f32 v224, -v27, v26, v224
    v_mul_f32 v224, v224, v28
    v_cvt_pk_bf16_f32 v224, v224, v224
    v_and_b32 v224, 0xffff0000, v224
    v_mul_f32 v225, s54, v224
    v_exp_f32 v225, v225
    v_and_b32_dpp v226, v224, v23 row_shl:4 row_mask:0xf bank_mask:0xf
    v_add_f32 v225, 1.0, v225
    v_rcp_f32 v225, v225
    s_nop 0
    v_mul_f32 v224, v224, v225
    v_cvt_pk_bf16_f32 v224, v224, v224
    v_and_b32 v224, 0xffff0000, v224
    v_mul_f32 v224, v224, v226
    v_cvt_pk_bf16_f32 v224, v224, v224
    ds_write_b16 v12, v224
L_join_45:
    s_waitcnt lgkmcnt(0)
    s_barrier
    ds_read_b128 v[176:179], v13 offset:768
    ds_read_b128 v[180:183], v13 offset:832
    s_waitcnt lgkmcnt(1)
    v_mfma_f32_16x16x32_bf16 v[192:195], v[176:179], v[144:147], 0
    s_waitcnt lgkmcnt(0)
    v_mfma_f32_16x16x32_bf16 v[192:195], v[180:183], v[148:151], v[192:195]
    s_mov_b32 exec_hi, 0
    s_nop 6
    v_bfi_b32 v152, v8, s69, v192
    global_store_dword v5, v152, s[14:15] offset:2048 sc1
    s_mov_b32 exec_hi, -1
    s_cmp_lg_u32 s30, 0
    s_cbranch_scc1 L_fin
    s_branch L_skip_46
L_idle_38:
    v_mov_b32 v238, s65
    s_branch L_join_45
L_skip_46:
    s_waitcnt vmcnt(0)
    global_load_dwordx4 v[224:227], v15, s[14:15] offset:2048 sc1
    global_load_dwordx4 v[228:231], v15, s[14:15] offset:3072 sc1
    s_branch L_pent_48
L_poll_47:
    s_sub_u32 s36, s36, 1
    s_cbranch_scc1 L_end
    global_load_dwordx4 v[224:227], v15, s[14:15] offset:2048 sc1
    global_load_dwordx4 v[228:231], v15, s[14:15] offset:3072 sc1
L_pent_48:
    s_waitcnt vmcnt(0)
    v_bitop3_b32 v175, v224, v228, s69 bitop3:0x7e
    v_cmp_ne_u32_sdwa vcc, v175, v18 src0_sel:BYTE_0 src1_sel:DWORD
    v_pk_add_f32 v[226:227], v[226:227], v[230:231]
    v_add_f32 v225, v225, v229
    v_and_b32 v224, s51, v224
    v_and_b32 v228, s51, v228
    v_add_f32 v224, v224, v228
    v_permlane32_swap_b32 v225, v227
    v_add_f32 v225, v225, v227
    v_permlane32_swap_b32 v224, v226
    v_add_f32 v224, v224, v226
    s_cbranch_vccnz L_poll_47
    s_nop 0
    v_permlane16_swap_b32 v224, v225
    v_add_f32 v224, v224, v225
    s_nop 1
    v_add_f32_dpp v224, v224, v224 row_ror:8 row_mask:0xf bank_mask:0xf
    s_nop 1
    v_add_f32_dpp v224, v224, v224 row_ror:4 row_mask:0xf bank_mask:0xf
    v_cvt_pk_bf16_f32 v224, v224, v224
    v_and_b32 v224, 0xffff0000, v224
    v_add_f32 v224, v224, v24
    v_cvt_pk_bf16_f32 v152, v224, v224
    s_mov_b32 exec_lo, 0x000f000f
    s_mov_b32 exec_hi, 0x000f000f
    global_store_short v10, v152, s[22:23]
L_fin:
L_end:
    s_endpgm
L_fastend:
L_slowtail:
    s_nop 1
    global_store_dword v200, v201, s[38:39] offset:0 sc1
    s_waitcnt vmcnt(0)
    s_mov_b64 exec, s[42:43]
    global_store_dwordx2 v202, v[236:237], s[38:39] offset:0 sc1
    s_mov_b64 exec, -1
    v_permlane16_swap_b32 v224, v225
    v_add_f32 v224, v224, v225
    s_nop 1
    v_add_f32_dpp v224, v224, v224 row_ror:8 row_mask:0xf bank_mask:0xf
    v_fma_f32 v224, -v27, v25, v224
    v_cvt_pk_bf16_f32 v224, v224, v224
    ds_write_b16 v11, v224 offset:256
    v_mov_b32 v168, s32
    v_mov_b32 v169, s32
    s_mov_b32 exec_lo, 0xff00ff00
    global_store_dwordx2 v148, v[168:169], s[40:41] sc1
    s_mov_b64 exec, -1
    v_fma_f32 v165, -v164, v164, v165
    v_max_f32 v165, 0, v165
    v_cvt_pk_bf16_f32 v165, v165, v165
    v_and_b32 v165, 0xffff0000, v165
    v_add_f32 v165, s53, v165
    v_cvt_pk_bf16_f32 v165, v165, v165
    v_and_b32 v165, 0xffff0000, v165
    v_sqrt_f32 v165, v165
    s_waitcnt lgkmcnt(0)
    s_barrier
    ds_read_b128 v[176:179], v13 offset:256
    ds_read_b128 v[180:183], v13 offset:320
    ds_read_b128 v[184:187], v13 offset:384
    ds_read_b128 v[188:191], v13 offset:448
    v_cvt_pk_bf16_f32 v165, v165, v165
    v_and_b32 v165, 0xffff0000, v165
    v_rcp_f32 v28, v165
    s_nop 0
    v_mul_f32 v17, s50, v28
    v_mov_b32 v234, s61
    s_waitcnt lgkmcnt(3)
    v_mfma_f32_16x16x32_bf16 v[192:195], v[176:179], v[48:51], 0
    v_mfma_f32_16x16x32_bf16 v[196:199], v[176:179], v[64:67], 0
    s_waitcnt lgkmcnt(2)
    v_mfma_f32_16x16x32_bf16 v[192:195], v[180:183], v[52:55], v[192:195]
    v_mfma_f32_16x16x32_bf16 v[196:199], v[180:183], v[68:71], v[196:199]
    s_waitcnt lgkmcnt(1)
    v_mfma_f32_16x16x32_bf16 v[192:195], v[184:187], v[56:59], v[192:195]
    v_mfma_f32_16x16x32_bf16 v[196:199], v[184:187], v[72:75], v[196:199]
    s_waitcnt lgkmcnt(0)
    v_mfma_f32_16x16x32_bf16 v[192:195], v[188:191], v[60:63], v[192:195]
    v_mfma_f32_16x16x32_bf16 v[196:199], v[188:191], v[76:79], v[196:199]
    ds_read_b64_tr_b16 v[80:81], v20 offset:20480
    ds_read_b64_tr_b16 v[82:83], v20 offset:21504
    ds_read_b64_tr_b16 v[84:85], v20 offset:28672
    ds_read_b64_tr_b16 v[86:87], v20 offset:29696
    ds_read_b64_tr_b16 v[88:89], v20 offset:36864
    ds_read_b64_tr_b16 v[90:91], v20 offset:37888
    ds_read_b64_tr_b16 v[92:93], v20 offset:45056
    ds_read_b64_tr_b16 v[94:95], v20 offset:46080
    v_max_f32 v152, v192, v196
    v_cndmask_b32 v153, v192, v196, s[56:57]
    s_nop 0
    v_max_f32_dpp v152, v152, v152 row_ror:8 row_mask:0xf bank_mask:0xf
    s_nop 1
    v_max_f32_dpp v152, v152, v152 row_ror:4 row_mask:0xf bank_mask:0xf
    s_nop 1
    v_max_f32_dpp v152, v152, v152 row_ror:2 row_mask:0xf bank_mask:0xf
    s_nop 1
    v_max_f32_dpp v152, v152, v152 row_ror:1 row_mask:0xf bank_mask:0xf
    v_mul_f32 v232, v17, v152
    v_fma_f32 v153, v153, v17, -v232
    v_exp_f32 v233, v153
    ds_write_b32 v19, v232 offset:896
    v_cvt_pk_bf16_f32 v153, v233, v233
    ds_write_b16 v4, v153 offset:1024
    ds_read_b64_tr_b16 v[96:97], v21 offset:20480
    ds_read_b64_tr_b16 v[98:99], v21 offset:21504
    ds_read_b64_tr_b16 v[100:101], v21 offset:28672
    ds_read_b64_tr_b16 v[102:103], v21 offset:29696
    ds_read_b64_tr_b16 v[104:105], v21 offset:36864
    ds_read_b64_tr_b16 v[106:107], v21 offset:37888
    ds_read_b64_tr_b16 v[108:109], v21 offset:45056
    ds_read_b64_tr_b16 v[110:111], v21 offset:46080
    v_add_f32_dpp v233, v233, v233 row_ror:8 row_mask:0xf bank_mask:0xf
    s_nop 1
    v_add_f32_dpp v233, v233, v233 row_ror:4 row_mask:0xf bank_mask:0xf
    s_nop 1
    v_add_f32_dpp v233, v233, v233 row_ror:2 row_mask:0xf bank_mask:0xf
    s_waitcnt lgkmcnt(0)
    s_barrier
    ds_read_b32 v156, v29 offset:896
    ds_read_b128 v[176:179], v13 offset:1024
    ds_read_b128 v[180:183], v13 offset:1088
    ds_read_b128 v[184:187], v13 offset:1152
    ds_read_b128 v[188:191], v13 offset:1216
    v_add_f32_dpp v233, v233, v233 row_ror:1 row_mask:0xf bank_mask:0xf
    s_nop 1
    v_add_f32_dpp v233, v233, v233 row_bcast:15 row_mask:0xa bank_mask:0xf
    s_mov_b64 exec, 0x10000
    global_store_dwordx4 v6, v[232:235], s[38:39] offset:512 sc1
    s_mov_b64 exec, -1
    s_waitcnt lgkmcnt(3)
    v_mfma_f32_16x16x32_bf16 v[192:195], v[176:179], v[80:83], 0
    v_max_f32_dpp v152, v156, v156 quad_perm:[1,0,3,2] row_mask:0xf bank_mask:0xf
    v_mfma_f32_16x16x32_bf16 v[196:199], v[176:179], v[96:99], 0
    s_waitcnt lgkmcnt(2)
    v_mfma_f32_16x16x32_bf16 v[200:203], v[180:183], v[84:87], 0
    v_max_f32_dpp v152, v152, v152 quad_perm:[2,3,0,1] row_mask:0xf bank_mask:0xf
    v_mfma_f32_16x16x32_bf16 v[204:207], v[180:183], v[100:103], 0
    v_sub_f32 v156, v156, v152
    s_waitcnt lgkmcnt(1)
    v_mfma_f32_16x16x32_bf16 v[208:211], v[184:187], v[88:91], 0
    v_exp_f32 v156, v156
    v_mfma_f32_16x16x32_bf16 v[212:215], v[184:187], v[104:107], 0
    s_waitcnt lgkmcnt(0)
    v_mov_b32_dpp v168, v156 quad_perm:[0,0,0,0] row_mask:0xf bank_mask:0xf
    v_mfma_f32_16x16x32_bf16 v[216:219], v[188:191], v[92:95], 0
    v_mov_b32_dpp v169, v156 quad_perm:[1,1,1,1] row_mask:0xf bank_mask:0xf
    v_mov_b32_dpp v170, v156 quad_perm:[2,2,2,2] row_mask:0xf bank_mask:0xf
    v_mfma_f32_16x16x32_bf16 v[220:223], v[188:191], v[108:111], 0
    global_load_dwordx4 v[248:251], v7, s[38:39] offset:512 sc1
    v_cndmask_b32 v160, v192, v196, s[56:57]
    v_cndmask_b32 v161, v200, v204, s[56:57]
    v_mul_f32 v152, v168, v160
    v_fmac_f32 v152, v169, v161
    v_cndmask_b32 v162, v208, v212, s[56:57]
    v_fmac_f32 v152, v170, v162
    v_mov_b32_dpp v171, v156 quad_perm:[3,3,3,3] row_mask:0xf bank_mask:0xf
    s_mov_b32 exec_hi, 0
    v_cndmask_b32 v163, v216, v220, s[56:57]
    v_fmac_f32 v152, v171, v163
    v_bfi_b32 v152, v8, s61, v152
    global_store_dword v3, v152, s[38:39] offset:2048 sc1
    s_mov_b32 exec_hi, -1
    global_load_dwordx4 v[252:255], v7, s[38:39] offset:512 sc1
    s_branch L_rent_50
L_ring_49:
    s_sub_u32 s36, s36, 1
    s_cbranch_scc1 L_end
    global_load_dwordx4 v[248:251], v7, s[38:39] offset:512 sc1
    s_waitcnt vmcnt(1)
    v_cmp_ne_u32 vcc, s61, v254
    v_max_f32_dpp v152, v252, v252 quad_perm:[1,0,3,2] row_mask:0xf bank_mask:0xf
    v_mov_b32 v164, v252
    v_mov_b32 v165, v253
    s_cbranch_vccz L_rdone_51
    global_load_dwordx4 v[252:255], v7, s[38:39] offset:512 sc1
    s_waitcnt vmcnt(1)
L_rent_50:
    s_waitcnt vmcnt(2)
    v_cmp_ne_u32 vcc, s61, v250
    v_max_f32_dpp v152, v248, v248 quad_perm:[1,0,3,2] row_mask:0xf bank_mask:0xf
    v_mov_b32 v164, v248
    v_mov_b32 v165, v249
    s_cbranch_vccnz L_ring_49
L_rdone_51:
    global_load_dwordx4 v[240:243], v2, s[38:39] offset:2048 sc1
    v_max_f32_dpp v152, v152, v152 quad_perm:[2,3,0,1] row_mask:0xf bank_mask:0xf
    s_nop 1
    v_max_f32_dpp v153, v152, v152 row_ror:8 row_mask:0xf bank_mask:0xf
    v_mov_b32 v154, v153
    s_nop 1
    v_permlane16_swap_b32 v153, v154
    v_max_f32 v153, v153, v154
    v_mov_b32 v154, v153
    s_nop 1
    v_permlane32_swap_b32 v153, v154
    v_max_f32 v153, v153, v154
    global_load_dwordx4 v[244:247], v2, s[38:39] offset:2048 sc1
    v_sub_f32 v164, v164, v153
    v_sub_f32 v152, v152, v153
    v_exp_f32 v164, v164
    v_exp_f32 v152, v152
    v_mul_f32 v164, v164, v165
    s_nop 1
    v_add_f32_dpp v164, v164, v164 quad_perm:[1,0,3,2] row_mask:0xf bank_mask:0xf
    s_nop 1
    v_add_f32_dpp v164, v164, v164 quad_perm:[2,3,0,1] row_mask:0xf bank_mask:0xf
    s_nop 1
    v_add_f32_dpp v164, v164, v164 row_ror:8 row_mask:0xf bank_mask:0xf
    v_mov_b32 v154, v164
    s_nop 1
    v_permlane16_swap_b32 v164, v154
    v_add_f32 v164, v164, v154
    v_mov_b32 v154, v164
    s_nop 1
    v_permlane32_swap_b32 v164, v154
    v_add_f32 v164, v164, v154
    v_rcp_f32 v164, v164
    s_nop 0
    v_mul_f32 v30, v152, v164
    s_branch L_rent_53
L_ring_52:
    s_sub_u32 s36, s36, 1
    s_cbranch_scc1 L_end
    global_load_dwordx4 v[240:243], v2, s[38:39] offset:2048 sc1
    s_waitcnt vmcnt(1)
    v_cmp_ne_u32_sdwa vcc, v244, s61 src0_sel:BYTE_0 src1_sel:BYTE_0
    v_and_b32 v244, s51, v244
    v_pk_mul_f32 v[246:247], v[246:247], v[30:31] op_sel_hi:[1,0]
    v_pk_mul_f32 v[244:245], v[244:245], v[30:31] op_sel_hi:[1,0]
    s_nop 1
    v_permlane32_swap_b32 v245, v247
    v_add_f32 v225, v245, v247
    v_permlane32_swap_b32 v244, v246
    v_add_f32 v224, v244, v246
    s_cbranch_vccz L_rdone_54
    global_load_dwordx4 v[244:247], v2, s[38:39] offset:2048 sc1
L_rent_53:
    s_waitcnt vmcnt(1)
    v_cmp_ne_u32_sdwa vcc, v240, s61 src0_sel:BYTE_0 src1_sel:BYTE_0
    v_and_b32 v240, s51, v240
    v_pk_mul_f32 v[242:243], v[242:243], v[30:31] op_sel_hi:[1,0]
    v_pk_mul_f32 v[240:241], v[240:241], v[30:31] op_sel_hi:[1,0]
    s_nop 1
    v_permlane32_swap_b32 v241, v243
    v_add_f32 v225, v241, v243
    v_permlane32_swap_b32 v240, v242
    v_add_f32 v224, v240, v242
    s_cbranch_vccnz L_ring_52
L_rdone_54:
    s_nop 0
    v_permlane16_swap_b32 v224, v225
    v_add_f32 v224, v224, v225
    s_nop 1
    v_add_f32_dpp v224, v224, v224 row_ror:8 row_mask:0xf bank_mask:0xf
    v_cvt_pk_bf16_f32 v224, v224, v224
    ds_write_b16 v11, v224 offset:512
    s_lshl_b32 s59, s28, 11
    s_add_u32 m0, s59, 69632
    s_nop 0
    global_load_lds_dwordx4 v146, s[16:17] offset:0 nt
    global_load_lds_dwordx4 v147, s[16:17] offset:1024 nt
    s_waitcnt lgkmcnt(0)
    s_barrier
    ds_read_b128 v[176:179], v13 offset:512
    ds_read_b64_tr_b16 v[112:113], v22 offset:0
    ds_read_b64_tr_b16 v[114:115], v22 offset:512
    ds_read_b128 v[180:183], v13 offset:576
    ds_read_b64_tr_b16 v[116:117], v22 offset:4096
    ds_read_b64_tr_b16 v[118:119], v22 offset:4608
    ds_read_b128 v[184:187], v13 offset:640
    ds_read_b64_tr_b16 v[120:121], v22 offset:8192
    ds_read_b64_tr_b16 v[122:123], v22 offset:8704
    ds_read_b128 v[188:191], v13 offset:704
    ds_read_b64_tr_b16 v[124:125], v22 offset:12288
    ds_read_b64_tr_b16 v[126:127], v22 offset:12800
    s_waitcnt lgkmcnt(9)
    v_mfma_f32_16x16x32_bf16 v[192:195], v[176:179], v[112:115], 0
    s_waitcnt lgkmcnt(6)
    v_mfma_f32_16x16x32_bf16 v[192:195], v[180:183], v[116:119], v[192:195]
    s_waitcnt lgkmcnt(3)
    v_mfma_f32_16x16x32_bf16 v[192:195], v[184:187], v[120:123], v[192:195]
    s_waitcnt lgkmcnt(0)
    v_mfma_f32_16x16x32_bf16 v[192:195], v[188:191], v[124:127], v[192:195]
    s_mov_b32 exec_hi, 0
    s_nop 6
    v_bfi_b32 v152, v8, s66, v192
    global_store_dword v5, v152, s[40:41] offset:0 sc1
    s_mov_b32 exec_hi, -1
    v_mov_b32 v234, s62
    v_cndmask_b32 v237, v234, v235, s[46:47]
    s_lshl_b32 s59, s28, 11
    s_add_u32 m0, s59, 77824
    s_nop 0
    global_load_lds_dwordx4 v146, s[18:19] offset:0 nt
    global_load_lds_dwordx4 v147, s[18:19] offset:1024 nt
    s_cmp_eq_u32 s28, 3
    s_cbranch_scc1 L_now2_55
    s_min_u32 s59, s28, 2
    s_lshl_b32 s59, s59, 11
    s_add_u32 m0, s59, 86016
    s_nop 0
    global_load_lds_dwordx4 v144, s[20:21] offset:0 nt
    global_load_lds_dwordx4 v145, s[4:5] offset:1024 nt
L_now2_55:
    s_waitcnt vmcnt(0)
    global_load_dwordx4 v[224:227], v15, s[40:41] offset:0 sc1
    global_load_dwordx4 v[228:231], v15, s[40:41] offset:1024 sc1
    s_branch L_pent_57
L_poll_56:
    s_sub_u32 s36, s36, 1
    s_cbranch_scc1 L_end
    global_load_dwordx4 v[224:227], v15, s[40:41] offset:0 sc1
    global_load_dwordx4 v[228:231], v15, s[40:41] offset:1024 sc1
L_pent_57:
    s_waitcnt vmcnt(0)
    v_bitop3_b32 v175, v224, v228, s66 bitop3:0x7e
    v_cmp_ne_u32_sdwa vcc, v175, v18 src0_sel:BYTE_0 src1_sel:DWORD
    v_pk_add_f32 v[226:227], v[226:227], v[230:231]
    v_add_f32 v225, v225, v229
    v_and_b32 v224, s51, v224
    v_and_b32 v228, s51, v228
    v_add_f32 v224, v224, v228
    v_permlane32_swap_b32 v225, v227
    v_add_f32 v225, v225, v227
    v_permlane32_swap_b32 v224, v226
    v_add_f32 v224, v224, v226
    s_cbranch_vccnz L_poll_56
    s_nop 0
    v_permlane16_swap_b32 v224, v225
    v_add_f32 v224, v224, v225
    s_nop 1
    v_add_f32_dpp v224, v224, v224 row_ror:8 row_mask:0xf bank_mask:0xf
    s_nop 1
    v_add_f32_dpp v224, v224, v224 row_ror:4 row_mask:0xf bank_mask:0xf
    v_cvt_pk_bf16_f32 v224, v224, v224
    v_and_b32 v224, 0xffff0000, v224
    v_add_f32 v224, v224, v24
    v_cvt_pk_bf16_f32 v152, v224, v224
    ds_write_b16 v10, v152 offset:0
    v_and_b32 v236, 0xffff0000, v152
    v_mul_f32 v159, v236, v236
    v_and_b32 v24, 0xffff0000, v152
    s_nop 0
    v_permlane32_swap_b32 v236, v159
    v_add_f32 v236, v236, v159
    s_nop 1
    v_add_f32_dpp v236, v236, v236 quad_perm:[1,0,3,2] row_mask:0xf bank_mask:0xf
    s_nop 1
    v_add_f32_dpp v236, v236, v236 quad_perm:[2,3,0,1] row_mask:0xf bank_mask:0xf
    s_nop 1
    v_add_f32_dpp v236, v236, v236 row_bcast:15 row_mask:0xa bank_mask:0xf
    s_mov_b64 exec, s[42:43]
    global_store_dwordx2 v9, v[236:237], s[38:39] offset:0 sc1
    s_mov_b64 exec, -1
    s_cmp_eq_u32 s28, 3
    s_waitcnt lgkmcnt(0)
    s_barrier
    ds_read_b128 v[176:179], v14 offset:0
    ds_read_b64_tr_b16 v[128:129], v22 offset:16384
    ds_read_b64_tr_b16 v[130:131], v22 offset:16896
    ds_read_b64_tr_b16 v[136:137], v22 offset:24576
    ds_read_b64_tr_b16 v[138:139], v22 offset:25088
    ds_read_b128 v[180:183], v14 offset:64
    ds_read_b64_tr_b16 v[132:133], v22 offset:20480
    ds_read_b64_tr_b16 v[134:135], v22 offset:20992
    ds_read_b64_tr_b16 v[140:141], v22 offset:28672
    ds_read_b64_tr_b16 v[142:143], v22 offset:29184
    s_cbranch_scc1 L_idle_58
    s_waitcnt lgkmcnt(7)
    v_mfma_f32_16x16x32_bf16 v[192:195], v[176:179], v[128:131], 0
    s_waitcnt lgkmcnt(5)
    v_mfma_f32_16x16x32_bf16 v[196:199], v[176:179], v[136:139], 0
    global_load_dwordx4 v[248:251], v7, s[38:39] offset:0 sc1
    s_waitcnt lgkmcnt(2)
    v_mfma_f32_16x16x32_bf16 v[192:195], v[180:183], v[132:135], v[192:195]
    s_waitcnt lgkmcnt(0)
    v_mfma_f32_16x16x32_bf16 v[196:199], v[180:183], v[140:143], v[196:199]
    s_nop 7
    v_cndmask_b32 v152, v192, v196, s[56:57]
    v_bfi_b32 v152, v8, s62, v152
    global_store_dword v3, v152, s[38:39] offset:0 sc1
    global_load_dwordx4 v[252:255], v7, s[38:39] offset:0 sc1
    s_branch L_rent_60
L_ring_59:
    s_sub_u32 s36, s36, 1
    s_cbranch_scc1 L_end
    global_load_dwordx4 v[248:251], v7, s[38:39] offset:0 sc1
    s_waitcnt vmcnt(1)
    v_cmp_ne_u32 vcc, s62, v253
    v_permlane32_swap_b32 v252, v254
    v_add_f32 v164, v252, v254
    s_cbranch_vccz L_rdone_61
    global_load_dwordx4 v[252:255], v7, s[38:39] offset:0 sc1
    s_waitcnt vmcnt(1)
L_rent_60:
    s_waitcnt vmcnt(2)
    v_cmp_ne_u32 vcc, s62, v249
    v_permlane32_swap_b32 v248, v250
    v_add_f32 v164, v248, v250
    s_cbranch_vccnz L_ring_59
L_rdone_61:
    global_load_dwordx4 v[240:243], v2, s[38:39] offset:0 sc1
    global_load_dwordx4 v[208:211], v2, s[38:39] offset:1024 sc1
    v_mov_b32 v165, v164
    s_nop 1
    v_permlane16_swap_b32 v164, v165
    v_add_f32 v164, v164, v165
    s_nop 1
    v_add_f32_dpp v164, v164, v164 row_ror:8 row_mask:0xf bank_mask:0xf
    s_nop 1
    v_add_f32_dpp v164, v164, v164 quad_perm:[1,0,3,2] row_mask:0xf bank_mask:0xf
    s_nop 1
    v_add_f32_dpp v164, v164, v164 quad_perm:[2,3,0,1] row_mask:0xf bank_mask:0xf
    v_mul_f32 v164, s52, v164
    v_mov_b32 v165, v164
    s_nop 1
    v_permlane32_swap_b32 v164, v165
    v_cvt_pk_bf16_f32 v27, v164, v164
    v_and_b32 v27, 0xffff0000, v27
    global_load_dwordx4 v[244:247], v2, s[38:39] offset:0 sc1
    global_load_dwordx4 v[212:215], v2, s[38:39] offset:1024 sc1
    v_fma_f32 v165, -v164, v164, v165
    v_max_f32 v165, 0, v165
    v_cvt_pk_bf16_f32 v165, v165, v165
    v_and_b32 v165, 0xffff0000, v165
    v_add_f32 v165, s53, v165
    v_cvt_pk_bf16_f32 v165, v165, v165
    v_and_b32 v165, 0xffff0000, v165
    v_sqrt_f32 v165, v165
    s_nop 0
    v_cvt_pk_bf16_f32 v165, v165, v165
    v_and_b32 v165, 0xffff0000, v165
    v_rcp_f32 v28, v165
    v_and_b32 v153, 32, v1
    v_lshlrev_b32 v153, 6, v153
    v_sub_u32 v153, v22, v153
    ds_read_b64_tr_b16 v[144:145], v22 offset:32768
    ds_read_b64_tr_b16 v[146:147], v22 offset:33280
    ds_read_b64_tr_b16 v[148:149], v153 offset:36864
    ds_read_b64_tr_b16 v[150:151], v153 offset:37376
    s_branch L_rent_63
L_ring_62:
    s_sub_u32 s36, s36, 1
    s_cbranch_scc1 L_end
    global_load_dwordx4 v[240:243], v2, s[38:39] offset:0 sc1
    global_load_dwordx4 v[208:211], v2, s[38:39] offset:1024 sc1
    s_waitcnt vmcnt(2)
    v_bitop3_b32 v175, v244, v212, s62 bitop3:0x7e
    v_cmp_ne_u32_sdwa vcc, v175, v18 src0_sel:BYTE_0 src1_sel:DWORD
    v_and_b32 v244, s51, v244
    v_and_b32 v212, s51, v212
    v_permlane32_swap_b32 v245, v247
    v_permlane32_swap_b32 v213, v215
    v_add_f32 v225, v245, v247
    v_add_f32 v229, v213, v215
    v_permlane32_swap_b32 v244, v246
    v_permlane32_swap_b32 v212, v214
    v_add_f32 v228, v212, v214
    v_add_f32 v224, v244, v246
    s_cbranch_vccz L_rdone_64
    global_load_dwordx4 v[244:247], v2, s[38:39] offset:0 sc1
    global_load_dwordx4 v[212:215], v2, s[38:39] offset:1024 sc1
L_rent_63:
    s_waitcnt vmcnt(2)
    v_bitop3_b32 v175, v240, v208, s62 bitop3:0x7e
    v_cmp_ne_u32_sdwa vcc, v175, v18 src0_sel:BYTE_0 src1_sel:DWORD
    v_and_b32 v240, s51, v240
    v_and_b32 v208, s51, v208
    v_permlane32_swap_b32 v241, v243
    v_permlane32_swap_b32 v209, v211
    v_add_f32 v225, v241, v243
    v_add_f32 v229, v209, v211
    v_permlane32_swap_b32 v240, v242
    v_permlane32_swap_b32 v208, v210
    v_add_f32 v228, v208, v210
    v_add_f32 v224, v240, v242
    s_cbranch_vccnz L_ring_62
L_rdone_64:
    v_permlane16_swap_b32 v228, v229
    v_add_f32 v228, v228, v229
    v_permlane16_swap_b32 v224, v225
    v_add_f32 v224, v224, v225
    v_add_f32_dpp v26, v228, v228 row_ror:8 row_mask:0xf bank_mask:0xf
    s_nop 0
    v_add_f32_dpp v224, v224, v224 row_ror:8 row_mask:0xf bank_mask:0xf
    v_fma_f32 v224, -v27, v26, v224
    v_mul_f32 v224, v224, v28
    v_cvt_pk_bf16_f32 v224, v224, v224
    v_and_b32 v224, 0xffff0000, v224
    v_mul_f32 v225, s54, v224
    v_exp_f32 v225, v225
    v_and_b32_dpp v226, v224, v23 row_shl:4 row_mask:0xf bank_mask:0xf
    v_add_f32 v225, 1.0, v225
    v_rcp_f32 v225, v225
    s_nop 0
    v_mul_f32 v224, v224, v225
    v_cvt_pk_bf16_f32 v224, v224, v224
    v_and_b32 v224, 0xffff0000, v224
    v_mul_f32 v224, v224, v226
    v_cvt_pk_bf16_f32 v224, v224, v224
    ds_write_b16 v12, v224
L_join_65:
    s_waitcnt lgkmcnt(0)
    s_barrier
    ds_read_b128 v[176:179], v13 offset:768
    ds_read_b128 v[180:183], v13 offset:832
    s_not_b32 s4, s66
    s_xor_b32 s5, s31, 8192
    v_mov_b32 v156, s31
    s_waitcnt lgkmcnt(1)
    v_mfma_f32_16x16x32_bf16 v[192:195], v[176:179], v[144:147], 0
    s_waitcnt lgkmcnt(0)
    v_mfma_f32_16x16x32_bf16 v[192:195], v[180:183], v[148:151], v[192:195]
    global_load_dword v157, v156, s[26:27] sc1
    s_load_dword s4, s[26:27], s5
    s_mov_b32 exec_hi, 0
    s_nop 4
    v_bfi_b32 v152, v8, s67, v192
    global_store_dword v5, v152, s[40:41] offset:2048 sc1
    s_mov_b32 exec_hi, -1
    v_mov_b32 v234, s63
    v_cndmask_b32 v237, v234, v235, s[46:47]
    s_lshr_b32 s55, s28, 1
    s_xor_b32 s59, s55, 1
    s_mul_i32 s55, s55, 0x22000
    s_mul_i32 s59, s59, 0x22000
    s_not_b32 s6, s66
    s_waitcnt vmcnt(1)
    s_cmp_lg_u32 s4, s6
    s_cselect_b32 s55, s59, s55
    v_xor_b32 v15, s55, v16
    s_branch L_skip_66
L_idle_58:
    v_and_b32 v153, 32, v1
    v_lshlrev_b32 v153, 6, v153
    v_sub_u32 v153, v22, v153
    ds_read_b64_tr_b16 v[144:145], v22 offset:32768
    ds_read_b64_tr_b16 v[146:147], v22 offset:33280
    ds_read_b64_tr_b16 v[148:149], v153 offset:36864
    ds_read_b64_tr_b16 v[150:151], v153 offset:37376
    s_cmp_lg_u32 s2, 255
    s_cbranch_scc1 L_join_65
    s_add_u32 s55, s32, 16
    v_mov_b32 v154, s55
    v_lshlrev_b32 v155, 2, v1
    s_mov_b32 exec_hi, 0
    global_store_dword v155, v154, s[26:27]
    s_mov_b64 exec, -1
    s_branch L_join_65
L_skip_66:
    s_waitcnt vmcnt(0)
    global_load_dwordx4 v[224:227], v15, s[40:41] offset:2048 sc1
    global_load_dwordx4 v[228:231], v15, s[40:41] offset:3072 sc1
    s_branch L_pent_68
L_poll_67:
    s_sub_u32 s36, s36, 1
    s_cbranch_scc1 L_end
    global_load_dwordx4 v[224:227], v15, s[40:41] offset:2048 sc1
    global_load_dwordx4 v[228:231], v15, s[40:41] offset:3072 sc1
L_pent_68:
    s_waitcnt vmcnt(0)
    v_bitop3_b32 v175, v224, v228, s67 bitop3:0x7e
    v_cmp_ne_u32_sdwa vcc, v175, v18 src0_sel:BYTE_0 src1_sel:DWORD
    v_pk_add_f32 v[226:227], v[226:227], v[230:231]
    v_add_f32 v225, v225, v229
    v_and_b32 v224, s51, v224
    v_and_b32 v228, s51, v228
    v_add_f32 v224, v224, v228
    v_permlane32_swap_b32 v225, v227
    v_add_f32 v225, v225, v227
    v_permlane32_swap_b32 v224, v226
    v_add_f32 v224, v224, v226
    s_cbranch_vccnz L_poll_67
    s_nop 0
    v_permlane16_swap_b32 v224, v225
    v_add_f32 v224, v224, v225
    s_nop 1
    v_add_f32_dpp v224, v224, v224 row_ror:8 row_mask:0xf bank_mask:0xf
    s_nop 1
    v_add_f32_dpp v224, v224, v224 row_ror:4 row_mask:0xf bank_mask:0xf
    v_cvt_pk_bf16_f32 v224, v224, v224
    v_and_b32 v224, 0xffff0000, v224
    v_add_f32 v224, v224, v24
    v_cvt_pk_bf16_f32 v152, v224, v224
    ds_write_b16 v10, v152 offset:0
    v_and_b32 v236, 0xffff0000, v152
    v_mul_f32 v159, v236, v236
    v_and_b32 v24, 0xffff0000, v152
    s_nop 0
    v_permlane32_swap_b32 v236, v159
    v_add_f32 v236, v236, v159
    s_nop 1
    v_add_f32_dpp v236, v236, v236 quad_perm:[1,0,3,2] row_mask:0xf bank_mask:0xf
    s_nop 1
    v_add_f32_dpp v236, v236, v236 quad_perm:[2,3,0,1] row_mask:0xf bank_mask:0xf
    s_nop 1
    v_add_f32_dpp v236, v236, v236 row_bcast:15 row_mask:0xa bank_mask:0xf
    s_mov_b64 exec, s[42:43]
    global_store_dwordx2 v9, v[236:237], s[38:39] offset:512 sc1
    s_mov_b64 exec, -1
    s_waitcnt lgkmcnt(0)
    s_barrier
    ds_read_b128 v[176:179], v13 offset:0
    ds_read_b128 v[180:183], v13 offset:64
    s_waitcnt lgkmcnt(1)
    v_mfma_f32_16x16x32_bf16 v[192:195], v[176:179], v[32:35], 0
    v_mfma_f32_16x16x32_bf16 v[196:199], v[176:179], v[40:43], 0
    global_load_dwordx4 v[248:251], v7, s[38:39] offset:512 sc1
    s_waitcnt lgkmcnt(0)
    v_mfma_f32_16x16x32_bf16 v[192:195], v[180:183], v[36:39], v[192:195]
    v_mfma_f32_16x16x32_bf16 v[196:199], v[180:183], v[44:47], v[196:199]
    s_mov_b32 exec_hi, 0
    s_nop 6
    v_cndmask_b32 v152, v192, v196, s[56:57]
    v_bfi_b32 v152, v8, s63, v152
    global_store_dword v3, v152, s[38:39] offset:2048 sc1
    s_mov_b32 exec_hi, -1
    global_load_dwordx4 v[252:255], v7, s[38:39] offset:512 sc1
    s_branch L_rent_70
L_ring_69:
    s_sub_u32 s36, s36, 1
    s_cbranch_scc1 L_end
    global_load_dwordx4 v[248:251], v7, s[38:39] offset:512 sc1
    s_waitcnt vmcnt(1)
    v_cmp_ne_u32 vcc, s63, v253
    v_permlane32_swap_b32 v252, v254
    v_add_f32 v164, v252, v254
    s_cbranch_vccz L_rdone_71
    global_load_dwordx4 v[252:255], v7, s[38:39] offset:512 sc1
    s_waitcnt vmcnt(1)
L_rent_70:
    s_waitcnt vmcnt(2)
    v_cmp_ne_u32 vcc, s63, v249
    v_permlane32_swap_b32 v248, v250
    v_add_f32 v164, v248, v250
    s_cbranch_vccnz L_ring_69
L_rdone_71:
    global_load_dwordx4 v[240:243], v2, s[38:39] offset:2048 sc1
    v_mov_b32 v165, v164
    s_nop 1
    v_permlane16_swap_b32 v164, v165
    v_add_f32 v164, v164, v165
    s_nop 1
    v_add_f32_dpp v164, v164, v164 row_ror:8 row_mask:0xf bank_mask:0xf
    s_nop 1
    v_add_f32_dpp v164, v164, v164 quad_perm:[1,0,3,2] row_mask:0xf bank_mask:0xf
    s_nop 1
    v_add_f32_dpp v164, v164, v164 quad_perm:[2,3,0,1] row_mask:0xf bank_mask:0xf
    v_mul_f32 v164, s52, v164
    v_mov_b32 v165, v164
    s_nop 1
    v_permlane32_swap_b32 v164, v165
    v_cvt_pk_bf16_f32 v27, v164, v164
    v_and_b32 v27, 0xffff0000, v27
    global_load_dwordx4 v[244:247], v2, s[38:39] offset:2048 sc1
    s_branch L_rent_73
L_ring_72:
    s_sub_u32 s36, s36, 1
    s_cbranch_scc1 L_end
    global_load_dwordx4 v[240:243], v2, s[38:39] offset:2048 sc1
    s_waitcnt vmcnt(1)
    v_cmp_ne_u32_sdwa vcc, v244, s63 src0_sel:BYTE_0 src1_sel:BYTE_0
    v_and_b32 v244, s51, v244
    v_permlane32_swap_b32 v245, v247
    v_add_f32 v225, v245, v247
    v_permlane32_swap_b32 v244, v246
    v_add_f32 v224, v244, v246
    s_cbranch_vccz L_rdone_74
    global_load_dwordx4 v[244:247], v2, s[38:39] offset:2048 sc1
L_rent_73:
    s_waitcnt vmcnt(1)
    v_cmp_ne_u32_sdwa vcc, v240, s63 src0_sel:BYTE_0 src1_sel:BYTE_0
    v_and_b32 v240, s51, v240
    v_permlane32_swap_b32 v241, v243
    v_add_f32 v225, v241, v243
    v_permlane32_swap_b32 v240, v242
    v_add_f32 v224, v240, v242
    s_cbranch_vccnz L_ring_72
L_rdone_74:
    s_nop 0
    v_permlane16_swap_b32 v224, v225
    v_add_f32 v224, v224, v225
    s_nop 1
    v_add_f32_dpp v224, v224, v224 row_ror:8 row_mask:0xf bank_mask:0xf
    v_fma_f32 v224, -v27, v25, v224
    v_cvt_pk_bf16_f32 v224, v224, v224
    ds_write_b16 v11, v224 offset:256
    v_fma_f32 v165, -v164, v164, v165
    v_max_f32 v165, 0, v165
    v_cvt_pk_bf16_f32 v165, v165, v165
    v_and_b32 v165, 0xffff0000, v165
    v_add_f32 v165, s53, v165
    v_cvt_pk_bf16_f32 v165, v165, v165
    v_and_b32 v165, 0xffff0000, v165
    v_sqrt_f32 v165, v165
    s_waitcnt lgkmcnt(0)
    s_barrier
    ds_read_b128 v[176:179], v13 offset:256
    ds_read_b128 v[180:183], v13 offset:320
    ds_read_b128 v[184:187], v13 offset:384
    ds_read_b128 v[188:191], v13 offset:448
    v_cvt_pk_bf16_f32 v165, v165, v165
    v_and_b32 v165, 0xffff0000, v165
    v_rcp_f32 v28, v165
    s_nop 0
    v_mul_f32 v17, s50, v28
    v_mov_b32 v234, s64
    s_waitcnt lgkmcnt(3)
    v_mfma_f32_16x16x32_bf16 v[192:195], v[176:179], v[48:51], 0
    v_mfma_f32_16x16x32_bf16 v[196:199], v[176:179], v[64:67], 0
    s_waitcnt lgkmcnt(2)
    v_mfma_f32_16x16x32_bf16 v[192:195], v[180:183], v[52:55], v[192:195]
    v_mfma_f32_16x16x32_bf16 v[196:199], v[180:183], v[68:71], v[196:199]
    s_waitcnt lgkmcnt(1)
    v_mfma_f32_16x16x32_bf16 v[192:195], v[184:187], v[56:59], v[192:195]
    v_mfma_f32_16x16x32_bf16 v[196:199], v[184:187], v[72:75], v[196:199]
    s_waitcnt lgkmcnt(0)
    v_mfma_f32_16x16x32_bf16 v[192:195], v[188:191], v[60:63], v[192:195]
    v_mfma_f32_16x16x32_bf16 v[196:199], v[188:191], v[76:79], v[196:199]
    s_nop 7
    v_max_f32 v152, v192, v196
    v_cndmask_b32 v153, v192, v196, s[56:57]
    s_nop 0
    v_max_f32_dpp v152, v152, v152 row_ror:8 row_mask:0xf bank_mask:0xf
    s_nop 1
    v_max_f32_dpp v152, v152, v152 row_ror:4 row_mask:0xf bank_mask:0xf
    s_nop 1
    v_max_f32_dpp v152, v152, v152 row_ror:2 row_mask:0xf bank_mask:0xf
    s_nop 1
    v_max_f32_dpp v152, v152, v152 row_ror:1 row_mask:0xf bank_mask:0xf
    v_mul_f32 v232, v17, v152
    v_fma_f32 v153, v153, v17, -v232
    v_exp_f32 v233, v153
    ds_write_b32 v19, v232 offset:896
    v_cvt_pk_bf16_f32 v153, v233, v233
    ds_write_b16 v4, v153 offset:1024
    v_add_f32_dpp v233, v233, v233 row_ror:8 row_mask:0xf bank_mask:0xf
    s_nop 1
    v_add_f32_dpp v233, v233, v233 row_ror:4 row_mask:0xf bank_mask:0xf
    s_nop 1
    v_add_f32_dpp v233, v233, v233 row_ror:2 row_mask:0xf bank_mask:0xf
    s_waitcnt lgkmcnt(0)
    s_barrier
    ds_read_b32 v156, v29 offset:896
    ds_read_b128 v[176:179], v13 offset:1024
    ds_read_b128 v[180:183], v13 offset:1088
    ds_read_b128 v[184:187], v13 offset:1152
    ds_read_b128 v[188:191], v13 offset:1216
    v_add_f32_dpp v233, v233, v233 row_ror:1 row_mask:0xf bank_mask:0xf
    s_nop 1
    v_add_f32_dpp v233, v233, v233 row_bcast:15 row_mask:0xa bank_mask:0xf
    s_mov_b64 exec, 0x10000
    global_store_dwordx4 v6, v[232:235], s[38:39] offset:0 sc1
    s_mov_b64 exec, -1
    s_waitcnt lgkmcnt(3)
    v_mfma_f32_16x16x32_bf16 v[192:195], v[176:179], v[80:83], 0
    v_max_f32_dpp v152, v156, v156 quad_perm:[1,0,3,2] row_mask:0xf bank_mask:0xf
    v_mfma_f32_16x16x32_bf16 v[196:199], v[176:179], v[96:99], 0
    s_waitcnt lgkmcnt(2)
    v_mfma_f32_16x16x32_bf16 v[200:203], v[180:183], v[84:87], 0
    v_max_f32_dpp v152, v152, v152 quad_perm:[2,3,0,1] row_mask:0xf bank_mask:0xf
    v_mfma_f32_16x16x32_bf16 v[204:207], v[180:183], v[100:103], 0
    v_sub_f32 v156, v156, v152
    s_waitcnt lgkmcnt(1)
    v_mfma_f32_16x16x32_bf16 v[208:211], v[184:187], v[88:91], 0
    v_exp_f32 v156, v156
    v_mfma_f32_16x16x32_bf16 v[212:215], v[184:187], v[104:107], 0
    s_waitcnt lgkmcnt(0)
    v_mov_b32_dpp v168, v156 quad_perm:[0,0,0,0] row_mask:0xf bank_mask:0xf
    v_mfma_f32_16x16x32_bf16 v[216:219], v[188:191], v[92:95], 0
    v_mov_b32_dpp v169, v156 quad_perm:[1,1,1,1] row_mask:0xf bank_mask:0xf
    v_mov_b32_dpp v170, v156 quad_perm:[2,2,2,2] row_mask:0xf bank_mask:0xf
    v_mfma_f32_16x16x32_bf16 v[220:223], v[188:191], v[108:111], 0
    global_load_dwordx4 v[248:251], v7, s[38:39] offset:0 sc1
    v_cndmask_b32 v160, v192, v196, s[56:57]
    v_cndmask_b32 v161, v200, v204, s[56:57]
    v_mul_f32 v152, v168, v160
    v_fmac_f32 v152, v169, v161
    v_cndmask_b32 v162, v208, v212, s[56:57]
    v_fmac_f32 v152, v170, v162
    v_mov_b32_dpp v171, v156 quad_perm:[3,3,3,3] row_mask:0xf bank_mask:0xf
    s_mov_b32 exec_hi, 0
    v_cndmask_b32 v163, v216, v220, s[56:57]
    v_fmac_f32 v152, v171, v163
    v_bfi_b32 v152, v8, s64, v152
    global_store_dword v3, v152, s[38:39] offset:0 sc1
    s_mov_b32 exec_hi, -1
    global_load_dwordx4 v[252:255], v7, s[38:39] offset:0 sc1
    s_branch L_rent_76
L_ring_75:
    s_sub_u32 s36, s36, 1
    s_cbranch_scc1 L_end
    global_load_dwordx4 v[248:251], v7, s[38:39] offset:0 sc1
    s_waitcnt vmcnt(1)
    v_cmp_ne_u32 vcc, s64, v254
    v_max_f32_dpp v152, v252, v252 quad_perm:[1,0,3,2] row_mask:0xf bank_mask:0xf
    v_mov_b32 v164, v252
    v_mov_b32 v165, v253
    s_cbranch_vccz L_rdone_77
    global_load_dwordx4 v[252:255], v7, s[38:39] offset:0 sc1
    s_waitcnt vmcnt(1)
L_rent_76:
    s_waitcnt vmcnt(2)
    v_cmp_ne_u32 vcc, s64, v250
    v_max_f32_dpp v152, v248, v248 quad_perm:[1,0,3,2] row_mask:0xf bank_mask:0xf
    v_mov_b32 v164, v248
    v_mov_b32 v165, v249
    s_cbranch_vccnz L_ring_75
L_rdone_77:
    global_load_dwordx4 v[240:243], v2, s[38:39] offset:0 sc1
    v_max_f32_dpp v152, v152, v152 quad_perm:[2,3,0,1] row_mask:0xf bank_mask:0xf
    s_nop 1
    v_max_f32_dpp v153, v152, v152 row_ror:8 row_mask:0xf bank_mask:0xf
    v_mov_b32 v154, v153
    s_nop 1
    v_permlane16_swap_b32 v153, v154
    v_max_f32 v153, v153, v154
    v_mov_b32 v154, v153
    s_nop 1
    v_permlane32_swap_b32 v153, v154
    v_max_f32 v153, v153, v154
    global_load_dwordx4 v[244:247], v2, s[38:39] offset:0 sc1
    v_sub_f32 v164, v164, v153
    v_sub_f32 v152, v152, v153
    v_exp_f32 v164, v164
    v_exp_f32 v152, v152
    v_mul_f32 v164, v164, v165
    s_nop 1
    v_add_f32_dpp v164, v164, v164 quad_perm:[1,0,3,2] row_mask:0xf bank_mask:0xf
    s_nop 1
    v_add_f32_dpp v164, v164, v164 quad_perm:[2,3,0,1] row_mask:0xf bank_mask:0xf
    s_nop 1
    v_add_f32_dpp v164, v164, v164 row_ror:8 row_mask:0xf bank_mask:0xf
    v_mov_b32 v154, v164
    s_nop 1
    v_permlane16_swap_b32 v164, v154
    v_add_f32 v164, v164, v154
    v_mov_b32 v154, v164
    s_nop 1
    v_permlane32_swap_b32 v164, v154
    v_add_f32 v164, v164, v154
    v_rcp_f32 v164, v164
    s_nop 0
    v_mul_f32 v30, v152, v164
    s_branch L_rent_79
L_ring_78:
    s_sub_u32 s36, s36, 1
    s_cbranch_scc1 L_end
    global_load_dwordx4 v[240:243], v2, s[38:39] offset:0 sc1
    s_waitcnt vmcnt(1)
    v_cmp_ne_u32_sdwa vcc, v244, s64 src0_sel:BYTE_0 src1_sel:BYTE_0
    v_and_b32 v244, s51, v244
    v_pk_mul_f32 v[246:247], v[246:247], v[30:31] op_sel_hi:[1,0]
    v_pk_mul_f32 v[244:245], v[244:245], v[30:31] op_sel_hi:[1,0]
    s_nop 1
    v_permlane32_swap_b32 v245, v247
    v_add_f32 v225, v245, v247
    v_permlane32_swap_b32 v244, v246
    v_add_f32 v224, v244, v246
    s_cbranch_vccz L_rdone_80
    global_load_dwordx4 v[244:247], v2, s[38:39] offset:0 sc1
L_rent_79:
    s_waitcnt vmcnt(1)
    v_cmp_ne_u32_sdwa vcc, v240, s64 src0_sel:BYTE_0 src1_sel:BYTE_0
    v_and_b32 v240, s51, v240
    v_pk_mul_f32 v[242:243], v[242:243], v[30:31] op_sel_hi:[1,0]
    v_pk_mul_f32 v[240:241], v[240:241], v[30:31] op_sel_hi:[1,0]
    s_nop 1
    v_permlane32_swap_b32 v241, v243
    v_add_f32 v225, v241, v243
    v_permlane32_swap_b32 v240, v242
    v_add_f32 v224, v240, v242
    s_cbranch_vccnz L_ring_78
L_rdone_80:
    s_nop 0
    v_permlane16_swap_b32 v224, v225
    v_add_f32 v224, v224, v225
    s_nop 1
    v_add_f32_dpp v224, v224, v224 row_ror:8 row_mask:0xf bank_mask:0xf
    v_cvt_pk_bf16_f32 v224, v224, v224
    ds_write_b16 v11, v224 offset:512
    s_waitcnt lgkmcnt(0)
    s_barrier
    ds_read_b128 v[176:179], v13 offset:512
    ds_read_b128 v[180:183], v13 offset:576
    ds_read_b128 v[184:187], v13 offset:640
    ds_read_b128 v[188:191], v13 offset:704
    s_waitcnt lgkmcnt(3)
    v_mfma_f32_16x16x32_bf16 v[192:195], v[176:179], v[112:115], 0
    s_waitcnt lgkmcnt(2)
    v_mfma_f32_16x16x32_bf16 v[192:195], v[180:183], v[116:119], v[192:195]
    s_waitcnt lgkmcnt(1)
    v_mfma_f32_16x16x32_bf16 v[192:195], v[184:187], v[120:123], v[192:195]
    s_waitcnt lgkmcnt(0)
    v_mfma_f32_16x16x32_bf16 v[192:195], v[188:191], v[124:127], v[192:195]
    s_mov_b32 exec_hi, 0
    s_nop 6
    v_bfi_b32 v152, v8, s68, v192
    global_store_dword v5, v152, s[14:15] offset:0 sc1
    s_mov_b32 exec_hi, -1
    v_mov_b32 v234, s65
    v_cndmask_b32 v237, v234, v235, s[46:47]
    s_waitcnt vmcnt(0)
    global_load_dwordx4 v[224:227], v15, s[14:15] offset:0 sc1
    global_load_dwordx4 v[228:231], v15, s[14:15] offset:1024 sc1
    s_branch L_pent_82
L_poll_81:
    s_sub_u32 s36, s36, 1
    s_cbranch_scc1 L_end
    global_load_dwordx4 v[224:227], v15, s[14:15] offset:0 sc1
    global_load_dwordx4 v[228:231], v15, s[14:15] offset:1024 sc1
L_pent_82:
    s_waitcnt vmcnt(0)
    v_bitop3_b32 v175, v224, v228, s68 bitop3:0x7e
    v_cmp_ne_u32_sdwa vcc, v175, v18 src0_sel:BYTE_0 src1_sel:DWORD
    v_pk_add_f32 v[226:227], v[226:227], v[230:231]
    v_add_f32 v225, v225, v229
    v_and_b32 v224, s51, v224
    v_and_b32 v228, s51, v228
    v_add_f32 v224, v224, v228
    v_permlane32_swap_b32 v225, v227
    v_add_f32 v225, v225, v227
    v_permlane32_swap_b32 v224, v226
    v_add_f32 v224, v224, v226
    s_cbranch_vccnz L_poll_81
    s_nop 0
    v_permlane16_swap_b32 v224, v225
    v_add_f32 v224, v224, v225
    s_nop 1
    v_add_f32_dpp v224, v224, v224 row_ror:8 row_mask:0xf bank_mask:0xf
    s_nop 1
    v_add_f32_dpp v224, v224, v224 row_ror:4 row_mask:0xf bank_mask:0xf
    v_cvt_pk_bf16_f32 v224, v224, v224
    v_and_b32 v224, 0xffff0000, v224
    v_add_f32 v224, v224, v24
    v_cvt_pk_bf16_f32 v152, v224, v224
    ds_write_b16 v10, v152 offset:0
    v_and_b32 v236, 0xffff0000, v152
    v_mul_f32 v159, v236, v236
    v_and_b32 v24, 0xffff0000, v152
    s_nop 0
    v_permlane32_swap_b32 v236, v159
    v_add_f32 v236, v236, v159
    s_nop 1
    v_add_f32_dpp v236, v236, v236 quad_perm:[1,0,3,2] row_mask:0xf bank_mask:0xf
    s_nop 1
    v_add_f32_dpp v236, v236, v236 quad_perm:[2,3,0,1] row_mask:0xf bank_mask:0xf
    s_nop 1
    v_add_f32_dpp v236, v236, v236 row_bcast:15 row_mask:0xa bank_mask:0xf
    s_mov_b64 exec, s[42:43]
    global_store_dwordx2 v9, v[236:237], s[38:39] offset:512 sc1
    s_mov_b64 exec, -1
    s_cmp_eq_u32 s28, 3
    s_waitcnt lgkmcnt(0)
    s_barrier
    ds_read_b128 v[176:179], v13 offset:0
    ds_read_b128 v[180:183], v13 offset:64
    s_cbranch_scc1 L_idle_83
    s_waitcnt lgkmcnt(1)
    v_mfma_f32_16x16x32_bf16 v[192:195], v[176:179], v[128:131], 0
    v_mfma_f32_16x16x32_bf16 v[196:199], v[176:179], v[136:139], 0
    global_load_dwordx4 v[248:251], v7, s[38:39] offset:512 sc1
    s_waitcnt lgkmcnt(0)
    v_mfma_f32_16x16x32_bf16 v[192:195], v[180:183], v[132:135], v[192:195]
    v_mfma_f32_16x16x32_bf16 v[196:199], v[180:183], v[140:143], v[196:199]
    s_mov_b32 exec_hi, 0
    s_nop 6
    v_cndmask_b32 v152, v192, v196, s[56:57]
    v_bfi_b32 v152, v8, s65, v152
    global_store_dword v3, v152, s[38:39] offset:2048 sc1
    s_mov_b32 exec_hi, -1
    global_load_dwordx4 v[252:255], v7, s[38:39] offset:512 sc1
    s_branch L_rent_85
L_ring_84:
    s_sub_u32 s36, s36, 1
    s_cbranch_scc1 L_end
    global_load_dwordx4 v[248:251], v7, s[38:39] offset:512 sc1
    s_waitcnt vmcnt(1)
    v_cmp_ne_u32 vcc, s65, v253
    v_permlane32_swap_b32 v252, v254
    v_add_f32 v164, v252, v254
    s_cbranch_vccz L_rdone_86
    global_load_dwordx4 v[252:255], v7, s[38:39] offset:512 sc1
    s_waitcnt vmcnt(1)
L_rent_85:
    s_waitcnt vmcnt(2)
    v_cmp_ne_u32 vcc, s65, v249
    v_permlane32_swap_b32 v248, v250
    v_add_f32 v164, v248, v250
    s_cbranch_vccnz L_ring_84
L_rdone_86:
    global_load_dwordx4 v[240:243], v2, s[38:39] offset:2048 sc1
    v_mov_b32 v165, v164
    s_nop 1
    v_permlane16_swap_b32 v164, v165
    v_add_f32 v164, v164, v165
    s_nop 1
    v_add_f32_dpp v164, v164, v164 row_ror:8 row_mask:0xf bank_mask:0xf
    s_nop 1
    v_add_f32_dpp v164, v164, v164 quad_perm:[1,0,3,2] row_mask:0xf bank_mask:0xf
    s_nop 1
    v_add_f32_dpp v164, v164, v164 quad_perm:[2,3,0,1] row_mask:0xf bank_mask:0xf
    v_mul_f32 v164, s52, v164
    v_mov_b32 v165, v164
    s_nop 1
    v_permlane32_swap_b32 v164, v165
    v_cvt_pk_bf16_f32 v27, v164, v164
    v_and_b32 v27, 0xffff0000, v27
    global_load_dwordx4 v[244:247], v2, s[38:39] offset:2048 sc1
    v_fma_f32 v165, -v164, v164, v165
    v_max_f32 v165, 0, v165
    v_cvt_pk_bf16_f32 v165, v165, v165
    v_and_b32 v165, 0xffff0000, v165
    v_add_f32 v165, s53, v165
    v_cvt_pk_bf16_f32 v165, v165, v165
    v_and_b32 v165, 0xffff0000, v165
    v_sqrt_f32 v165, v165
    s_nop 0
    v_cvt_pk_bf16_f32 v165, v165, v165
    v_and_b32 v165, 0xffff0000, v165
    v_rcp_f32 v28, v165
    s_branch L_rent_88
L_ring_87:
    s_sub_u32 s36, s36, 1
    s_cbranch_scc1 L_end
    global_load_dwordx4 v[240:243], v2, s[38:39] offset:2048 sc1
    s_waitcnt vmcnt(1)
    v_cmp_ne_u32_sdwa vcc, v244, s65 src0_sel:BYTE_0 src1_sel:BYTE_0
    v_and_b32 v244, s51, v244
    v_permlane32_swap_b32 v245, v247
    v_add_f32 v225, v245, v247
    v_permlane32_swap_b32 v244, v246
    v_add_f32 v224, v244, v246
    s_cbranch_vccz L_rdone_89
    global_load_dwordx4 v[244:247], v2, s[38:39] offset:2048 sc1
L_rent_88:
    s_waitcnt vmcnt(1)
    v_cmp_ne_u32_sdwa vcc, v240, s65 src0_sel:BYTE_0 src1_sel:BYTE_0
    v_and_b32 v240, s51, v240
    v_permlane32_swap_b32 v241, v243
    v_add_f32 v225, v241, v243
    v_permlane32_swap_b32 v240, v242
    v_add_f32 v224, v240, v242
    s_cbranch_vccnz L_ring_87
L_rdone_89:
    s_nop 0
    v_permlane16_swap_b32 v224, v225
    v_add_f32 v224, v224, v225
    s_nop 1
    v_add_f32_dpp v224, v224, v224 row_ror:8 row_mask:0xf bank_mask:0xf
    v_fma_f32 v224, -v27, v26, v224
    v_mul_f32 v224, v224, v28
    v_cvt_pk_bf16_f32 v224, v224, v224
    v_and_b32 v224, 0xffff0000, v224
    v_mul_f32 v225, s54, v224
    v_exp_f32 v225, v225
    v_and_b32_dpp v226, v224, v23 row_shl:4 row_mask:0xf bank_mask:0xf
    v_add_f32 v225, 1.0, v225
    v_rcp_f32 v225, v225
    s_nop 0
    v_mul_f32 v224, v224, v225
    v_cvt_pk_bf16_f32 v224, v224, v224
    v_and_b32 v224, 0xffff0000, v224
    v_mul_f32 v224, v224, v226
    v_cvt_pk_bf16_f32 v224, v224, v224
    ds_write_b16 v12, v224
L_join_90:
    s_waitcnt lgkmcnt(0)
    s_barrier
    ds_read_b128 v[176:179], v13 offset:768
    ds_read_b128 v[180:183], v13 offset:832
    s_waitcnt lgkmcnt(1)
    v_mfma_f32_16x16x32_bf16 v[192:195], v[176:179], v[144:147], 0
    s_waitcnt lgkmcnt(0)
    v_mfma_f32_16x16x32_bf16 v[192:195], v[180:183], v[148:151], v[192:195]
    s_mov_b32 exec_hi, 0
    s_nop 6
    v_bfi_b32 v152, v8, s69, v192
    global_store_dword v5, v152, s[14:15] offset:2048 sc1
    s_mov_b32 exec_hi, -1
    s_cmp_lg_u32 s30, 0
    s_cbranch_scc1 L_fin
    s_branch L_skip_91
L_idle_83:
    v_mov_b32 v238, s65
    s_branch L_join_90
L_skip_91:
    s_waitcnt vmcnt(0)
    global_load_dwordx4 v[224:227], v15, s[14:15] offset:2048 sc1
    global_load_dwordx4 v[228:231], v15, s[14:15] offset:3072 sc1
    s_branch L_pent_93
L_poll_92:
    s_sub_u32 s36, s36, 1
    s_cbranch_scc1 L_end
    global_load_dwordx4 v[224:227], v15, s[14:15] offset:2048 sc1
    global_load_dwordx4 v[228:231], v15, s[14:15] offset:3072 sc1
L_pent_93:
    s_waitcnt vmcnt(0)
    v_bitop3_b32 v175, v224, v228, s69 bitop3:0x7e
    v_cmp_ne_u32_sdwa vcc, v175, v18 src0_sel:BYTE_0 src1_sel:DWORD
    v_pk_add_f32 v[226:227], v[226:227], v[230:231]
    v_add_f32 v225, v225, v229
    v_and_b32 v224, s51, v224
    v_and_b32 v228, s51, v228
    v_add_f32 v224, v224, v228
    v_permlane32_swap_b32 v225, v227
    v_add_f32 v225, v225, v227
    v_permlane32_swap_b32 v224, v226
    v_add_f32 v224, v224, v226
    s_cbranch_vccnz L_poll_92
    s_nop 0
    v_permlane16_swap_b32 v224, v225
    v_add_f32 v224, v224, v225
    s_nop 1
    v_add_f32_dpp v224, v224, v224 row_ror:8 row_mask:0xf bank_mask:0xf
    s_nop 1
    v_add_f32_dpp v224, v224, v224 row_ror:4 row_mask:0xf bank_mask:0xf
    v_cvt_pk_bf16_f32 v224, v224, v224
    v_and_b32 v224, 0xffff0000, v224
    v_add_f32 v224, v224, v24
    v_cvt_pk_bf16_f32 v152, v224, v224
    s_mov_b32 exec_lo, 0x000f000f
    s_mov_b32 exec_hi, 0x000f000f
    global_store_short v10, v152, s[22:23]
    s_branch L_fin
    s_endpgm
.section .rodata,"a"
.p2align 6
.amdhsa_kernel interleave_layers__sliding_block_cached__glu_gated_swiglu__decode_kernel
  .amdhsa_next_free_vgpr 256
  .amdhsa_next_free_sgpr 102
  .amdhsa_accum_offset 256
  .amdhsa_group_segment_fixed_size 0
  .amdhsa_kernarg_size 96
  .amdhsa_user_sgpr_count 2
  .amdhsa_user_sgpr_kernarg_segment_ptr 1
  .amdhsa_system_sgpr_workgroup_id_x 1
  .amdhsa_float_denorm_mode_32 3
.end_amdhsa_kernel
```
